```python
import torch

def _softmax(x, axis=-1):
    return torch.softmax(x, dim=axis)
def _gelu(x):
    return torch.nn.functional.gelu(x, approximate="tanh")
def _silu(x):
    return torch.nn.functional.silu(x)
def _sigmoid(x):
    return torch.sigmoid(x)
def _layernorm(x, axis=-1, eps=1e-5):
    m = x.mean(dim=axis, keepdim=True)
    v = x.var(dim=axis, keepdim=True, unbiased=False)
    return (x - m) / torch.sqrt(v + eps)
def _scatter_add(tgt, idx, src, axis=0):
    return tgt.clone().index_add_(axis, idx, src)
def _segment_sum(src, seg, n):
    out = torch.zeros((n,) + src.shape[1:], dtype=src.dtype)
    return out.index_add_(0, seg, src)
def _pad(x, pw):
    flat = tuple(v for pair in reversed(pw) for v in pair)
    return torch.nn.functional.pad(x, flat)

kernel_name = 'recurrent_scan__ssm_conv_h3__moe_arch_mod__prompt'

def setup_inputs():

    _w = (lambda a: (lambda t: t.to(torch.bfloat16) if t.is_floating_point() else t)(torch.as_tensor(a)))
    def _A_setup():
        B, S, D = 1, 2048, 640
        ks = 4
        return {
            "q": _w((lambda *s: torch.randn(*s, dtype=torch.bfloat16) * 0.1)(B, S, D)),
            "k": _w((lambda *s: torch.randn(*s, dtype=torch.bfloat16) * 1.6)(B, S, D)),
            "v": _w((lambda *s: torch.randn(*s, dtype=torch.bfloat16) * 1.6)(B, S, D)),
            "shift_k": _w((lambda *s: torch.randn(*s, dtype=torch.bfloat16) * 1.6)(D, ks) * 0.5),
            "ssm_k": _w((lambda *s: torch.randn(*s, dtype=torch.bfloat16) * 1.6)(D, S) * (1.0 / S ** 0.5)),
            "ssm_D": _w((lambda *s: torch.randn(*s, dtype=torch.bfloat16) * 1.6)(D)),
        }
    _A_in = _A_setup()

    def _B_setup():
        B, S, D, F, C = 1, 2048, 640, 1536, 8
        return {
            "x": _w((lambda *s: torch.randn(*s, dtype=torch.bfloat16) * 0.1)(B, S, D)),
            "w_r": _w((lambda *s: torch.randn(*s, dtype=torch.bfloat16) * 1.6)(D)),
            "w_gate": _w((lambda *s: torch.randn(*s, dtype=torch.bfloat16) * 1.6)(D, F)),
            "w_up": _w((lambda *s: torch.randn(*s, dtype=torch.bfloat16) * 1.6)(D, F)),
            "w_down": _w((lambda *s: torch.randn(*s, dtype=torch.bfloat16) * 1.6)(F, D)),
        }
    _B_in = _B_setup()

    return {
        "A_q": _A_in["q"],
        "A_k": _A_in["k"],
        "A_v": _A_in["v"],
        "A_shift_k": _A_in["shift_k"],
        "A_ssm_k": _A_in["ssm_k"],
        "A_ssm_D": _A_in["ssm_D"],
        "B_x": _B_in["x"],
        "B_w_r": _B_in["w_r"],
        "B_w_gate": _B_in["w_gate"],
        "B_w_up": _B_in["w_up"],
        "B_w_down": _B_in["w_down"],
    }

def reference(A_q, A_k, A_v, A_shift_k, A_ssm_k, A_ssm_D, B_x, B_w_r, B_w_gate, B_w_up, B_w_down):
    def _A_ref(q, k, v, shift_k, ssm_k, ssm_D):
        B, S, D = q.shape
        ks = shift_k.shape[-1]
        k_pad = _pad(k, ((0, 0), (ks - 1, 0), (0, 0)))
        k_shift = torch.zeros_like(k)
        for t in range(ks):
            k_shift = k_shift + k_pad[:, t:t + S, :] * shift_k[:, ks - 1 - t][None, None, :]
        kv = k_shift * v
        L = 2 * S
        kv_pad = _pad(kv, ((0, 0), (0, S), (0, 0)))
        kf_pad = _pad(ssm_k, ((0, 0), (0, S)))
        kv_f = (lambda x, axes=(-2,-1): torch.fft.rfft2(x.float(), dim=axes))(kv_pad[:, None, :, :], axes=(1, 2))
        kf_f = (lambda x, axes=(-2,-1): torch.fft.rfft2(x.float(), dim=axes))(kf_pad[:, None, :], axes=(1, 2))
        kf_f = (lambda x, *d: x.permute(*d))(kf_f, 1, 2, 0)
        y_f = kv_f * kf_f[None, :, :, :]
        y = (lambda x, s, axes=(-2,-1): torch.fft.irfft2(x, s=s, dim=axes).to(torch.bfloat16))(y_f, (1, L), axes=(1, 2))[:, 0, :S, :]
        y = y + kv * ssm_D[None, None, :]
        return q * y

    def _B_ref(x, w_r, w_gate, w_up, w_down):
        B, S, D = x.shape
        C = 8
        r = x @ w_r
        idx = torch.argsort(-r, axis=-1)[:, :C]
        idx_e = (lambda x, n, axis: torch.repeat_interleave(x, n, dim=axis))(idx.reshape(B, C, 1), D, axis=2)
        x_sel = (lambda x, i, axis: torch.take_along_dim(x, i, dim=axis))(x, idx_e, axis=1)
        g = _silu(x_sel @ w_gate)
        u = x_sel @ w_up
        y = (g * u) @ w_down
        r_sel = _sigmoid((lambda x, i, axis: torch.take_along_dim(x, i, dim=axis))(r, idx, axis=1))
        y = y * r_sel.reshape(B, C, 1)
        b_off = (torch.arange(B) * S).reshape(B, 1)
        flat_idx = (idx + b_off).reshape(B * C)
        zero = (x * 0.0).reshape(B * S, D)
        upd = _scatter_add(zero, flat_idx, y.reshape(B * C, D), axis=0)
        return x + upd.reshape(B, S, D)

    x = A_q
    xn = _layernorm(x, axis=-1)
    s = _A_ref(xn, A_k, A_v, A_shift_k, A_ssm_k, A_ssm_D)
    g = _silu(_B_ref(xn, B_w_r, B_w_gate, B_w_up, B_w_down))
    return x + s * g
```

```asm
; @launch grid=(256,1,1) block=(576,1,1) lds=73472
.amdgcn_target "amdgcn-amd-amdhsa--gfx950"
.text
.p2align 12
.globl recurrent_scan__ssm_conv_h3__moe_arch_mod__prompt_kernel
.p2align 8
.type recurrent_scan__ssm_conv_h3__moe_arch_mod__prompt_kernel,@function
recurrent_scan__ssm_conv_h3__moe_arch_mod__prompt_kernel:
K_FIRST:
    s_cmp_ge_u32 s2, 256
    s_cbranch_scc1 K_END
    s_load_dwordx8 s[4:11], s[0:1], 0
    s_load_dwordx4 s[12:15], s[0:1], 32
    s_load_dwordx8 s[44:51], s[0:1], 56
    s_load_dwordx2 s[52:53], s[0:1], 88
    s_load_dwordx2 s[54:55], s[0:1], 104
    v_lshrrev_b32 v1, 6, v0
    s_and_b32 s16, s2, 7
    v_readfirstlane_b32 s3, v1
    s_lshr_b32 s17, s2, 3
    s_cmp_lg_u32 s3, 0
    s_cbranch_scc1 K_NOPF
    s_getpc_b64 s[20:21]
K_PC:
    s_sub_u32 s20, s20, K_PC-K_FIRST
    s_subb_u32 s21, s21, 0
    s_mov_b32 s22, K_END-K_FIRST
    s_mov_b32 s23, 0x20000
    s_lshl_b32 s24, s17, 10
    v_lshlrev_b32 v1, 7, v0
    s_mov_b64 exec, 0xff
    buffer_load_dword v71, v1, s[20:23], s24 offen
    s_mov_b64 exec, -1
K_NOPF:
    s_and_b32 s74, s17, 3
    s_and_b32 s75, s17, 24
    s_add_u32 s75, s75, s16
    s_lshl_b32 s75, s75, 1
    s_bfe_u32 s18, s17, 0x10002
    s_add_u32 s75, s75, s18
    s_cmp_ge_u32 s3, 4
    s_cbranch_scc1 K_T
    s_lshl_b32 s76, s75, 2
    s_add_u32 s76, s76, s74
    s_lshl_b32 s18, s76, 3
    s_lshl_b32 s19, s3, 1
    s_add_u32 s18, s18, s19
    v_and_b32 v1, 63, v0
    v_lshrrev_b32 v2, 5, v1
    v_add_u32 v2, s18, v2
    v_and_b32 v3, 31, v1
    v_lshlrev_b32 v4, 4, v3
    v_lshlrev_b32 v5, 3, v3
    v_mul_u32_u24 v6, 1280, v2
    v_add_u32 v7, v6, v5
    v_add_u32 v6, v6, v4
    v_mov_b32 v12, 0
    v_mov_b32 v13, 0
    v_mov_b32 v14, 0
    v_mov_b32 v15, 0
    v_mov_b32 v11, 61440
    s_waitcnt lgkmcnt(0)
    s_mov_b32 s20, s4
    s_mov_b32 s21, s5
    s_mov_b32 s22, 2621440
    s_mov_b32 s23, 0x20000
    buffer_load_dwordx4 v[72:75], v6, s[20:23], 0 offen
    buffer_load_dwordx4 v[76:79], v6, s[20:23], 0 offen offset:512
    buffer_load_dwordx2 v[80:81], v7, s[20:23], 0 offen offset:1024
    s_mov_b32 s24, s44
    s_mov_b32 s25, s45
    s_mov_b32 s26, 1280
    s_mov_b32 s27, 0x20000
    buffer_load_dwordx4 v[84:87], v4, s[24:27], 0 offen
    buffer_load_dwordx4 v[88:91], v4, s[24:27], 0 offen offset:512
    buffer_load_dwordx2 v[92:93], v5, s[24:27], 0 offen offset:1024
    s_branch K_L
K_T:
    s_sub_u32 s3, s3, 4
    s_mul_i32 s18, s74, 160
    s_lshl_b32 s19, s3, 5
    s_add_u32 s64, s18, s19
    s_lshl_b32 s19, s75, 5
    v_and_b32 v0, 63, v0
    v_and_b32 v1, 15, v0
    v_lshrrev_b32 v2, 4, v0
    v_lshl_add_u32 v1, v1, 1, s64
    v_lshl_add_u32 v2, v2, 3, s19
    v_mul_u32_u24 v3, 1280, v2
    v_lshl_add_u32 v3, v1, 1, v3
    v_subrev_u32 v4, 3840, v3
    v_cmp_eq_u32 vcc, 0, v2
    v_mov_b32 v5, 0x80000000
    s_nop 0
    v_cndmask_b32 v4, v4, v5, vcc
    v_lshlrev_b32 v5, 3, v1
    s_mov_b32 s18, 5120
    s_mov_b32 s22, 2621440
    s_mov_b32 s23, 0x20000
    s_mov_b32 s26, 2621440
    s_mov_b32 s27, 0x20000
    s_mov_b32 s30, 5120
    s_mov_b32 s31, 0x20000
    s_waitcnt lgkmcnt(0)
    s_mov_b64 s[20:21], s[6:7]
    buffer_load_dword v11, v3, s[20:23], 0 offen offset:0
    buffer_load_dword v12, v3, s[20:23], 0 offen offset:1280
    buffer_load_dword v13, v3, s[20:23], 0 offen offset:2560
    buffer_load_dword v14, v3, s[20:23], 0 offen offset:3840
    buffer_load_dword v15, v3, s[20:23], s18 offen offset:0
    buffer_load_dword v16, v3, s[20:23], s18 offen offset:1280
    buffer_load_dword v17, v3, s[20:23], s18 offen offset:2560
    buffer_load_dword v18, v3, s[20:23], s18 offen offset:3840
    buffer_load_dword v8, v4, s[20:23], 0 offen offset:0
    buffer_load_dword v9, v4, s[20:23], 0 offen offset:1280
    buffer_load_dword v10, v4, s[20:23], 0 offen offset:2560
    s_mov_b64 s[28:29], s[10:11]
    s_mov_b64 s[24:25], s[8:9]
    buffer_load_dwordx4 v[28:31], v5, s[28:31], 0 offen
    buffer_load_dword v20, v3, s[24:27], 0 offen offset:0
    buffer_load_dword v21, v3, s[24:27], 0 offen offset:1280
    buffer_load_dword v22, v3, s[24:27], 0 offen offset:2560
    buffer_load_dword v23, v3, s[24:27], 0 offen offset:3840
    buffer_load_dword v24, v3, s[24:27], s18 offen offset:0
    buffer_load_dword v25, v3, s[24:27], s18 offen offset:1280
    buffer_load_dword v26, v3, s[24:27], s18 offen offset:2560
    buffer_load_dword v27, v3, s[24:27], s18 offen offset:3840
    s_barrier
    s_mov_b32 s32, s4
    s_mov_b32 s33, s5
    s_mov_b32 s34, 2621440
    s_mov_b32 s35, 0x20000
    s_mul_i32 s40, s17, 60
    v_min_u32 v95, 59, v0
    v_add_u32 v95, s40, v95
    s_mov_b32 s40, 0x5556
    v_mul_u32_u24 v96, s40, v95
    v_lshrrev_b32 v96, 16, v96
    s_cmp_eq_u32 s3, 0
    s_cselect_b32 s76, s46, s48
    s_cselect_b32 s77, s47, s49
    s_cmp_eq_u32 s3, 2
    s_cselect_b32 s76, s50, s76
    s_cselect_b32 s77, s51, s77
    s_cselect_b32 s40, 0, 2688
    s_cselect_b32 s41, 640, 1
    s_mul_i32 s41, s41, s16
    s_mul_i32 s41, s41, 384
    s_cmp_ge_u32 s3, 2
    s_cselect_b32 s78, 0, 1966080
    s_mov_b32 s79, 0x20000
    v_mul_u32_u24 v96, s40, v96
    v_lshl_add_u32 v95, v95, 7, v96
    buffer_load_dword v97, v95, s[76:79], s41 offen
    s_mov_b32 s36, s52
    s_mov_b32 s37, s53
    s_mov_b32 s38, 2621440
    s_mov_b32 s39, 0x20000
    s_mov_b32 s60, s54
    s_mov_b32 s61, s55
    s_mov_b32 s62, 16777216
    s_mov_b32 s63, 0x20000
    s_mul_i32 s67, s64, 4224
    s_lshl_b32 s40, s75, 6
    s_sub_u32 s65, s67, s40
    s_add_u32 s65, s65, 1052608
    s_add_u32 s66, s65, 67584
    s_add_u32 s67, s67, s40
    s_add_u32 s67, s67, 4194304
    s_add_u32 s68, s67, 67584
    v_lshrrev_b32 v6, 2, v0
    v_and_b32 v90, 3, v0
    v_mul_u32_u24 v6, 4224, v6
    v_lshl_add_u32 v6, v90, 4, v6
    s_mul_i32 s40, s3, 2304
    s_add_u32 s40, s40, 61952
    v_lshrrev_b32 v91, 3, v0
    v_add_u32 v91, v91, v0
    v_lshl_add_u32 v91, v91, 4, s40
    v_and_b32 v90, 15, v0
    v_mul_u32_u24 v90, 144, v90
    v_lshrrev_b32 v93, 4, v0
    v_lshl_add_u32 v94, v93, 4, v90
    v_add_u32 v94, s40, v94
    v_sub_u32 v93, 3, v93
    v_lshl_add_u32 v90, v93, 4, v90
    v_add_u32 v90, s40, v90
    v_mov_b32 v92, 61440
    v_mov_b32 v93, 1
    v_lshlrev_b32 v5, 4, v2
    v_add_u32 v5, 65600, v5
    s_lshl_b32 s40, s64, 1
    s_add_u32 s40, s40, s75
    s_lshl_b32 s40, s40, 7
    s_add_u32 s40, s40, 524288
    v_mov_b32 v89, s40
    s_mov_b32 s70, 3216550459
    s_mov_b32 s71, 3216550459
    s_mov_b32 s72, 1.0
    s_mov_b32 s73, 1.0
    s_waitcnt vmcnt(9)
    v_lshlrev_b32 v32, 16, v28
    v_lshlrev_b32 v33, 16, v30
    v_and_b32 v34, 0xffff0000, v28
    v_and_b32 v35, 0xffff0000, v30
    v_lshlrev_b32 v36, 16, v29
    v_lshlrev_b32 v37, 16, v31
    v_and_b32 v38, 0xffff0000, v29
    v_and_b32 v39, 0xffff0000, v31
    v_lshlrev_b32 v40, 16, v8
    v_and_b32 v41, 0xffff0000, v8
    v_lshlrev_b32 v42, 16, v9
    v_and_b32 v43, 0xffff0000, v9
    v_lshlrev_b32 v44, 16, v10
    v_and_b32 v45, 0xffff0000, v10
    v_lshlrev_b32 v46, 16, v11
    v_and_b32 v47, 0xffff0000, v11
    v_lshlrev_b32 v48, 16, v12
    v_and_b32 v49, 0xffff0000, v12
    v_lshlrev_b32 v50, 16, v13
    v_and_b32 v51, 0xffff0000, v13
    v_lshlrev_b32 v52, 16, v14
    v_and_b32 v53, 0xffff0000, v14
    v_lshlrev_b32 v54, 16, v15
    v_and_b32 v55, 0xffff0000, v15
    v_lshlrev_b32 v56, 16, v16
    v_and_b32 v57, 0xffff0000, v16
    v_lshlrev_b32 v58, 16, v17
    v_and_b32 v59, 0xffff0000, v17
    v_lshlrev_b32 v60, 16, v18
    v_and_b32 v61, 0xffff0000, v18
    v_pk_mul_f32 v[64:65], v[40:41], v[38:39]
    v_pk_mul_f32 v[66:67], v[42:43], v[38:39]
    v_pk_mul_f32 v[68:69], v[44:45], v[38:39]
    v_pk_mul_f32 v[70:71], v[46:47], v[38:39]
    v_pk_mul_f32 v[72:73], v[48:49], v[38:39]
    v_pk_mul_f32 v[74:75], v[50:51], v[38:39]
    v_pk_mul_f32 v[76:77], v[52:53], v[38:39]
    v_pk_mul_f32 v[78:79], v[54:55], v[38:39]
    v_pk_fma_f32 v[64:65], v[42:43], v[36:37], v[64:65]
    v_pk_fma_f32 v[66:67], v[44:45], v[36:37], v[66:67]
    v_pk_fma_f32 v[68:69], v[46:47], v[36:37], v[68:69]
    v_pk_fma_f32 v[70:71], v[48:49], v[36:37], v[70:71]
    v_pk_fma_f32 v[72:73], v[50:51], v[36:37], v[72:73]
    v_pk_fma_f32 v[74:75], v[52:53], v[36:37], v[74:75]
    v_pk_fma_f32 v[76:77], v[54:55], v[36:37], v[76:77]
    v_pk_fma_f32 v[78:79], v[56:57], v[36:37], v[78:79]
    v_pk_fma_f32 v[64:65], v[44:45], v[34:35], v[64:65]
    v_pk_fma_f32 v[66:67], v[46:47], v[34:35], v[66:67]
    v_pk_fma_f32 v[68:69], v[48:49], v[34:35], v[68:69]
    v_pk_fma_f32 v[70:71], v[50:51], v[34:35], v[70:71]
    v_pk_fma_f32 v[72:73], v[52:53], v[34:35], v[72:73]
    v_pk_fma_f32 v[74:75], v[54:55], v[34:35], v[74:75]
    v_pk_fma_f32 v[76:77], v[56:57], v[34:35], v[76:77]
    v_pk_fma_f32 v[78:79], v[58:59], v[34:35], v[78:79]
    v_pk_fma_f32 v[64:65], v[46:47], v[32:33], v[64:65]
    v_pk_fma_f32 v[66:67], v[48:49], v[32:33], v[66:67]
    v_pk_fma_f32 v[68:69], v[50:51], v[32:33], v[68:69]
    v_pk_fma_f32 v[70:71], v[52:53], v[32:33], v[70:71]
    v_pk_fma_f32 v[72:73], v[54:55], v[32:33], v[72:73]
    v_pk_fma_f32 v[74:75], v[56:57], v[32:33], v[74:75]
    v_pk_fma_f32 v[76:77], v[58:59], v[32:33], v[76:77]
    v_pk_fma_f32 v[78:79], v[60:61], v[32:33], v[78:79]
    s_waitcnt vmcnt(1)
    v_lshlrev_b32 v40, 16, v20
    v_and_b32 v41, 0xffff0000, v20
    v_lshlrev_b32 v42, 16, v21
    v_and_b32 v43, 0xffff0000, v21
    v_lshlrev_b32 v44, 16, v22
    v_and_b32 v45, 0xffff0000, v22
    v_lshlrev_b32 v46, 16, v23
    v_and_b32 v47, 0xffff0000, v23
    v_lshlrev_b32 v48, 16, v24
    v_and_b32 v49, 0xffff0000, v24
    v_lshlrev_b32 v50, 16, v25
    v_and_b32 v51, 0xffff0000, v25
    v_lshlrev_b32 v52, 16, v26
    v_and_b32 v53, 0xffff0000, v26
    v_lshlrev_b32 v54, 16, v27
    v_and_b32 v55, 0xffff0000, v27
    v_pk_mul_f32 v[64:65], v[64:65], v[40:41]
    v_pk_mul_f32 v[66:67], v[66:67], v[42:43]
    v_pk_mul_f32 v[68:69], v[68:69], v[44:45]
    v_pk_mul_f32 v[70:71], v[70:71], v[46:47]
    v_pk_mul_f32 v[72:73], v[72:73], v[48:49]
    v_pk_mul_f32 v[74:75], v[74:75], v[50:51]
    v_pk_mul_f32 v[76:77], v[76:77], v[52:53]
    v_pk_mul_f32 v[78:79], v[78:79], v[54:55]
    v_cvt_pk_bf16_f32 v80, v78, v76
    v_cvt_pk_bf16_f32 v81, v74, v72
    v_cvt_pk_bf16_f32 v82, v70, v68
    v_cvt_pk_bf16_f32 v83, v66, v64
    ds_write_b128 v90, v[80:83] offset:0
    v_cvt_pk_bf16_f32 v84, v79, v77
    v_cvt_pk_bf16_f32 v85, v75, v73
    v_cvt_pk_bf16_f32 v86, v71, v69
    v_cvt_pk_bf16_f32 v87, v67, v65
    ds_write_b128 v90, v[84:87] offset:64
    ds_read_b128 v[64:67], v91
    ds_read_b128 v[68:71], v91 offset:1152
    s_waitcnt lgkmcnt(1)
    buffer_store_dwordx4 v[64:67], v6, s[60:63], s65 offen sc1
    s_waitcnt lgkmcnt(0)
    buffer_store_dwordx4 v[68:71], v6, s[60:63], s66 offen sc1
    s_mov_b64 exec, 1
    ds_add_u32 v92, v93 offset:24
    s_mov_b64 exec, -1
    s_mov_b32 s57, 0
LW_1:
    ds_read_b32 v88, v92 offset:12
    s_waitcnt lgkmcnt(0)
    v_cmp_gt_u32 vcc, 1, v88
    s_cbranch_vccz LW_1_x
    s_add_u32 s57, s57, 1
    s_cmp_lt_u32 s57, 100000
    s_cbranch_scc1 LW_1
LW_1_x:
    ds_read_b32 v88, v92 offset:16
    s_waitcnt vmcnt(0) lgkmcnt(0)
    s_mov_b64 exec, 1
    buffer_store_dword v88, v89, s[60:63], 0 offen sc1
    ds_add_u32 v92, v93 offset:32
    s_mov_b64 exec, -1
    v_readfirstlane_b32 s56, v88
    s_mov_b32 s57, 0
LW_2:
    ds_read_b32 v88, v92 offset:32
    s_waitcnt lgkmcnt(0)
    v_cmp_gt_u32 vcc, 5, v88
    s_cbranch_vccz LW_2_x
    s_add_u32 s57, s57, 1
    s_cmp_lt_u32 s57, 100000
    s_cbranch_scc1 LW_2
LW_2_x:
    s_cmp_lt_u32 s17, 20
    s_cbranch_scc1 TD_3
    s_cmp_eq_u32 s3, 4
    s_cbranch_scc1 TD_4
    s_sub_u32 s40, s17, 20
    s_mul_i32 s41, s16, 12
    s_add_u32 s40, s40, s41
    v_lshrrev_b32 v8, 1, v0
    v_mul_u32_u24 v8, 3072, v8
    v_and_b32 v9, 1, v0
    v_lshl_add_u32 v8, v9, 4, v8
    s_mul_i32 s41, s3, 491520
    s_lshl_b32 s42, s40, 5
    s_add_u32 s41, s41, s42
    s_mul_i32 s42, s3, 5120
    s_mul_i32 s40, s40, 20480
    s_mul_i32 s43, s3, 320
    s_add_u32 s40, s40, s43
    s_mov_b32 s43, 0xcccd
    s_mov_b32 s20, s46
    s_mov_b32 s21, s47
    s_mov_b32 s22, 1966080
    s_mov_b32 s23, 0x20000
    s_mov_b32 s24, s48
    s_mov_b32 s25, s49
    s_mov_b32 s26, 1966080
    s_mov_b32 s27, 0x20000
    s_mov_b32 s28, s50
    s_mov_b32 s29, s51
    s_mov_b32 s30, 1966080
    s_mov_b32 s31, 0x20000
    v_add_u32 v10, 0, v0
    v_mul_u32_u24 v9, s43, v10
    v_lshrrev_b32 v9, 20, v9
    v_mul_u32_u24 v9, 960, v9
    v_lshl_add_u32 v10, v10, 4, v9
    v_add_u32 v11, 64, v0
    v_mul_u32_u24 v9, s43, v11
    v_lshrrev_b32 v9, 20, v9
    v_mul_u32_u24 v9, 960, v9
    v_lshl_add_u32 v11, v11, 4, v9
    v_add_u32 v12, 128, v0
    v_mul_u32_u24 v9, s43, v12
    v_lshrrev_b32 v9, 20, v9
    v_mul_u32_u24 v9, 960, v9
    v_lshl_add_u32 v12, v12, 4, v9
    v_add_u32 v13, 192, v0
    v_mul_u32_u24 v9, s43, v13
    v_lshrrev_b32 v9, 20, v9
    v_mul_u32_u24 v9, 960, v9
    v_lshl_add_u32 v13, v13, 4, v9
    v_add_u32 v14, 256, v0
    v_mul_u32_u24 v9, s43, v14
    v_lshrrev_b32 v9, 20, v9
    v_mul_u32_u24 v9, 960, v9
    v_lshl_add_u32 v14, v14, 4, v9
    buffer_load_dwordx4 v[16:19], v5, s[60:63], 0 offen offset:0 sc1
    buffer_load_dwordx4 v[20:23], v5, s[60:63], 0 offen offset:16 sc1
    buffer_load_dwordx4 v[24:27], v5, s[60:63], 0 offen offset:32 sc1
    buffer_load_dwordx4 v[28:31], v5, s[60:63], 0 offen offset:48 sc1
    buffer_load_dword v98, v3, s[32:35], 0 offen offset:0
    buffer_load_dword v99, v3, s[32:35], 0 offen offset:1280
    buffer_load_dword v100, v3, s[32:35], 0 offen offset:2560
    buffer_load_dword v101, v3, s[32:35], 0 offen offset:3840
    buffer_load_dword v102, v3, s[32:35], s18 offen offset:0
    buffer_load_dword v103, v3, s[32:35], s18 offen offset:1280
    buffer_load_dword v104, v3, s[32:35], s18 offen offset:2560
    buffer_load_dword v105, v3, s[32:35], s18 offen offset:3840
    s_mov_b32 s57, 0
LW_5:
    ds_read_b32 v88, v92 offset:40
    s_waitcnt lgkmcnt(0)
    v_cmp_gt_u32 vcc, 4, v88
    s_cbranch_vccz LW_5_x
    s_add_u32 s57, s57, 1
    s_cmp_lt_u32 s57, 100000
    s_cbranch_scc1 LW_5
LW_5_x:
    s_add_u32 m0, s42, 0
    s_nop 0
    buffer_load_dwordx4 v8, s[20:23], s41 offen lds
    s_add_u32 m0, s42, 20480
    s_nop 0
    buffer_load_dwordx4 v8, s[24:27], s41 offen lds
    s_add_u32 s41, s41, 98304
    s_add_u32 m0, s42, 1024
    s_nop 0
    buffer_load_dwordx4 v8, s[20:23], s41 offen lds
    s_add_u32 m0, s42, 21504
    s_nop 0
    buffer_load_dwordx4 v8, s[24:27], s41 offen lds
    s_add_u32 s41, s41, 98304
    s_add_u32 m0, s42, 2048
    s_nop 0
    buffer_load_dwordx4 v8, s[20:23], s41 offen lds
    s_add_u32 m0, s42, 22528
    s_nop 0
    buffer_load_dwordx4 v8, s[24:27], s41 offen lds
    s_add_u32 s41, s41, 98304
    s_add_u32 m0, s42, 3072
    s_nop 0
    buffer_load_dwordx4 v8, s[20:23], s41 offen lds
    s_add_u32 m0, s42, 23552
    s_nop 0
    buffer_load_dwordx4 v8, s[24:27], s41 offen lds
    s_add_u32 s41, s41, 98304
    s_add_u32 m0, s42, 4096
    s_nop 0
    buffer_load_dwordx4 v8, s[20:23], s41 offen lds
    s_add_u32 m0, s42, 24576
    s_nop 0
    buffer_load_dwordx4 v8, s[24:27], s41 offen lds
    s_add_u32 s41, s41, 98304
    s_mov_b32 s57, 0
LW_6:
    ds_read_b32 v88, v92 offset:48
    s_waitcnt lgkmcnt(0)
    v_cmp_gt_u32 vcc, 1, v88
    s_cbranch_vccz LW_6_x
    s_add_u32 s57, s57, 1
    s_cmp_lt_u32 s57, 100000
    s_cbranch_scc1 LW_6
LW_6_x:
    s_add_u32 m0, s42, 40960
    s_nop 0
    buffer_load_dwordx4 v10, s[28:31], s40 offen lds
    s_add_u32 m0, s42, 41984
    s_nop 0
    buffer_load_dwordx4 v11, s[28:31], s40 offen lds
    s_add_u32 m0, s42, 43008
    s_nop 0
    buffer_load_dwordx4 v12, s[28:31], s40 offen lds
    s_add_u32 m0, s42, 44032
    s_nop 0
    buffer_load_dwordx4 v13, s[28:31], s40 offen lds
    s_add_u32 m0, s42, 45056
    s_nop 0
    buffer_load_dwordx4 v14, s[28:31], s40 offen lds
    s_waitcnt vmcnt(5)
    s_mov_b64 exec, 1
    ds_add_u32 v92, v93 offset:52
    s_mov_b64 exec, -1
    s_waitcnt vmcnt(0)
    s_mov_b64 exec, 1
    ds_add_u32 v92, v93 offset:56
    s_mov_b64 exec, -1
    s_branch TD_7
TD_4:
TD_3:
    buffer_load_dwordx4 v[16:19], v5, s[60:63], 0 offen offset:0 sc1
    buffer_load_dwordx4 v[20:23], v5, s[60:63], 0 offen offset:16 sc1
    buffer_load_dwordx4 v[24:27], v5, s[60:63], 0 offen offset:32 sc1
    buffer_load_dwordx4 v[28:31], v5, s[60:63], 0 offen offset:48 sc1
    buffer_load_dword v98, v3, s[32:35], 0 offen offset:0
    buffer_load_dword v99, v3, s[32:35], 0 offen offset:1280
    buffer_load_dword v100, v3, s[32:35], 0 offen offset:2560
    buffer_load_dword v101, v3, s[32:35], 0 offen offset:3840
    buffer_load_dword v102, v3, s[32:35], s18 offen offset:0
    buffer_load_dword v103, v3, s[32:35], s18 offen offset:1280
    buffer_load_dword v104, v3, s[32:35], s18 offen offset:2560
    buffer_load_dword v105, v3, s[32:35], s18 offen offset:3840
    s_waitcnt vmcnt(0)
TD_7:
    v_max3_u32 v72, v17, v19, v21
    v_max3_u32 v72, v72, v23, v25
    v_max3_u32 v72, v72, v27, v29
    v_max_u32 v72, v72, v31
    v_min3_u32 v73, v17, v19, v21
    v_min3_u32 v73, v73, v23, v25
    v_min3_u32 v73, v73, v27, v29
    v_min_u32 v73, v73, v31
    v_xor_b32 v72, s56, v72
    v_xor_b32 v73, s56, v73
    v_or_b32 v72, v72, v73
    v_cmp_ne_u32 vcc, 0, v72
    s_cbranch_vccz TS0_8
    s_mov_b64 exec, vcc
    s_mov_b32 s57, 0
TS_9:
    buffer_load_dwordx4 v[16:19], v5, s[60:63], 0 offen offset:0 sc1
    buffer_load_dwordx4 v[20:23], v5, s[60:63], 0 offen offset:16 sc1
    buffer_load_dwordx4 v[24:27], v5, s[60:63], 0 offen offset:32 sc1
    buffer_load_dwordx4 v[28:31], v5, s[60:63], 0 offen offset:48 sc1
    s_waitcnt vmcnt(0)
    v_max3_u32 v72, v17, v19, v21
    v_max3_u32 v72, v72, v23, v25
    v_max3_u32 v72, v72, v27, v29
    v_max_u32 v72, v72, v31
    v_min3_u32 v73, v17, v19, v21
    v_min3_u32 v73, v73, v23, v25
    v_min3_u32 v73, v73, v27, v29
    v_min_u32 v73, v73, v31
    v_xor_b32 v72, s56, v72
    v_xor_b32 v73, s56, v73
    v_or_b32 v72, v72, v73
    v_cmp_ne_u32 vcc, 0, v72
    s_and_b64 exec, exec, vcc
    s_cbranch_execz TS_9_x
    s_sleep 1
    s_add_u32 s57, s57, 1
    s_cmp_lt_u32 s57, 100000
    s_cbranch_scc1 TS_9
TS_9_x:
    s_mov_b64 exec, -1
TS0_8:
    v_and_b32 v64, 0xffff0000, v16
    v_lshlrev_b32 v16, 16, v16
    v_rcp_f32 v64, v64
    v_and_b32 v66, 0xffff0000, v18
    v_lshlrev_b32 v18, 16, v18
    v_rcp_f32 v66, v66
    v_and_b32 v68, 0xffff0000, v20
    v_lshlrev_b32 v20, 16, v20
    v_rcp_f32 v68, v68
    v_and_b32 v70, 0xffff0000, v22
    v_lshlrev_b32 v22, 16, v22
    v_rcp_f32 v70, v70
    v_and_b32 v72, 0xffff0000, v24
    v_lshlrev_b32 v24, 16, v24
    v_rcp_f32 v72, v72
    v_and_b32 v74, 0xffff0000, v26
    v_lshlrev_b32 v26, 16, v26
    v_rcp_f32 v74, v74
    v_and_b32 v76, 0xffff0000, v28
    v_lshlrev_b32 v28, 16, v28
    v_rcp_f32 v76, v76
    v_and_b32 v78, 0xffff0000, v30
    v_lshlrev_b32 v30, 16, v30
    v_rcp_f32 v78, v78
    v_lshlrev_b32 v32, 16, v98
    v_and_b32 v33, 0xffff0000, v98
    v_lshlrev_b32 v34, 16, v99
    v_and_b32 v35, 0xffff0000, v99
    v_lshlrev_b32 v36, 16, v100
    v_and_b32 v37, 0xffff0000, v100
    v_lshlrev_b32 v38, 16, v101
    v_and_b32 v39, 0xffff0000, v101
    v_lshlrev_b32 v40, 16, v102
    v_and_b32 v41, 0xffff0000, v102
    v_lshlrev_b32 v42, 16, v103
    v_and_b32 v43, 0xffff0000, v103
    v_lshlrev_b32 v44, 16, v104
    v_and_b32 v45, 0xffff0000, v104
    v_lshlrev_b32 v46, 16, v105
    v_and_b32 v47, 0xffff0000, v105
    v_pk_add_f32 v[48:49], v[32:33], v[16:17] op_sel_hi:[1,0] neg_lo:[0,1] neg_hi:[0,1]
    v_pk_add_f32 v[50:51], v[34:35], v[18:19] op_sel_hi:[1,0] neg_lo:[0,1] neg_hi:[0,1]
    v_pk_add_f32 v[52:53], v[36:37], v[20:21] op_sel_hi:[1,0] neg_lo:[0,1] neg_hi:[0,1]
    v_pk_add_f32 v[54:55], v[38:39], v[22:23] op_sel_hi:[1,0] neg_lo:[0,1] neg_hi:[0,1]
    v_pk_add_f32 v[56:57], v[40:41], v[24:25] op_sel_hi:[1,0] neg_lo:[0,1] neg_hi:[0,1]
    v_pk_add_f32 v[58:59], v[42:43], v[26:27] op_sel_hi:[1,0] neg_lo:[0,1] neg_hi:[0,1]
    v_pk_add_f32 v[60:61], v[44:45], v[28:29] op_sel_hi:[1,0] neg_lo:[0,1] neg_hi:[0,1]
    v_pk_add_f32 v[62:63], v[46:47], v[30:31] op_sel_hi:[1,0] neg_lo:[0,1] neg_hi:[0,1]
    v_cvt_pk_bf16_f32 v8, v48, v49
    v_cvt_pk_bf16_f32 v9, v50, v51
    v_cvt_pk_bf16_f32 v10, v52, v53
    v_cvt_pk_bf16_f32 v11, v54, v55
    v_cvt_pk_bf16_f32 v12, v56, v57
    v_cvt_pk_bf16_f32 v13, v58, v59
    v_cvt_pk_bf16_f32 v14, v60, v61
    v_cvt_pk_bf16_f32 v15, v62, v63
    v_lshlrev_b32 v48, 16, v8
    v_and_b32 v49, 0xffff0000, v8
    v_lshlrev_b32 v50, 16, v9
    v_and_b32 v51, 0xffff0000, v9
    v_lshlrev_b32 v52, 16, v10
    v_and_b32 v53, 0xffff0000, v10
    v_lshlrev_b32 v54, 16, v11
    v_and_b32 v55, 0xffff0000, v11
    v_lshlrev_b32 v56, 16, v12
    v_and_b32 v57, 0xffff0000, v12
    v_lshlrev_b32 v58, 16, v13
    v_and_b32 v59, 0xffff0000, v13
    v_lshlrev_b32 v60, 16, v14
    v_and_b32 v61, 0xffff0000, v14
    v_lshlrev_b32 v62, 16, v15
    v_and_b32 v63, 0xffff0000, v15
    v_pk_mul_f32 v[48:49], v[48:49], v[64:65] op_sel_hi:[1,0]
    v_pk_mul_f32 v[50:51], v[50:51], v[66:67] op_sel_hi:[1,0]
    v_pk_mul_f32 v[52:53], v[52:53], v[68:69] op_sel_hi:[1,0]
    v_pk_mul_f32 v[54:55], v[54:55], v[70:71] op_sel_hi:[1,0]
    v_pk_mul_f32 v[56:57], v[56:57], v[72:73] op_sel_hi:[1,0]
    v_pk_mul_f32 v[58:59], v[58:59], v[74:75] op_sel_hi:[1,0]
    v_pk_mul_f32 v[60:61], v[60:61], v[76:77] op_sel_hi:[1,0]
    v_pk_mul_f32 v[62:63], v[62:63], v[78:79] op_sel_hi:[1,0]
    v_cvt_pk_bf16_f32 v8, v48, v49
    v_cvt_pk_bf16_f32 v9, v50, v51
    v_cvt_pk_bf16_f32 v10, v52, v53
    v_cvt_pk_bf16_f32 v11, v54, v55
    v_cvt_pk_bf16_f32 v12, v56, v57
    v_cvt_pk_bf16_f32 v13, v58, v59
    v_cvt_pk_bf16_f32 v14, v60, v61
    v_cvt_pk_bf16_f32 v15, v62, v63
    v_lshlrev_b32 v48, 16, v8
    v_and_b32 v49, 0xffff0000, v8
    v_lshlrev_b32 v50, 16, v9
    v_and_b32 v51, 0xffff0000, v9
    v_lshlrev_b32 v52, 16, v10
    v_and_b32 v53, 0xffff0000, v10
    v_lshlrev_b32 v54, 16, v11
    v_and_b32 v55, 0xffff0000, v11
    v_lshlrev_b32 v56, 16, v12
    v_and_b32 v57, 0xffff0000, v12
    v_lshlrev_b32 v58, 16, v13
    v_and_b32 v59, 0xffff0000, v13
    v_lshlrev_b32 v60, 16, v14
    v_and_b32 v61, 0xffff0000, v14
    v_lshlrev_b32 v62, 16, v15
    v_and_b32 v63, 0xffff0000, v15
    v_pk_mul_f32 v[64:65], v[48:49], s[70:71]
    v_pk_mul_f32 v[66:67], v[50:51], s[70:71]
    v_pk_mul_f32 v[68:69], v[52:53], s[70:71]
    v_pk_mul_f32 v[70:71], v[54:55], s[70:71]
    v_pk_mul_f32 v[72:73], v[56:57], s[70:71]
    v_pk_mul_f32 v[74:75], v[58:59], s[70:71]
    v_pk_mul_f32 v[76:77], v[60:61], s[70:71]
    v_pk_mul_f32 v[78:79], v[62:63], s[70:71]
    v_exp_f32 v64, v64
    v_exp_f32 v65, v65
    v_exp_f32 v66, v66
    v_exp_f32 v67, v67
    v_exp_f32 v68, v68
    v_exp_f32 v69, v69
    v_exp_f32 v70, v70
    v_exp_f32 v71, v71
    v_exp_f32 v72, v72
    v_exp_f32 v73, v73
    v_exp_f32 v74, v74
    v_exp_f32 v75, v75
    v_exp_f32 v76, v76
    v_exp_f32 v77, v77
    v_exp_f32 v78, v78
    v_exp_f32 v79, v79
    v_pk_mul_f32 v[48:49], v[48:49], v[48:49]
    v_pk_add_f32 v[64:65], v[64:65], s[72:73]
    v_pk_mul_f32 v[50:51], v[50:51], v[50:51]
    v_pk_add_f32 v[66:67], v[66:67], s[72:73]
    v_pk_mul_f32 v[52:53], v[52:53], v[52:53]
    v_pk_add_f32 v[68:69], v[68:69], s[72:73]
    v_pk_mul_f32 v[54:55], v[54:55], v[54:55]
    v_pk_add_f32 v[70:71], v[70:71], s[72:73]
    v_pk_mul_f32 v[56:57], v[56:57], v[56:57]
    v_pk_add_f32 v[72:73], v[72:73], s[72:73]
    v_pk_mul_f32 v[58:59], v[58:59], v[58:59]
    v_pk_add_f32 v[74:75], v[74:75], s[72:73]
    v_pk_mul_f32 v[60:61], v[60:61], v[60:61]
    v_pk_add_f32 v[76:77], v[76:77], s[72:73]
    v_pk_mul_f32 v[62:63], v[62:63], v[62:63]
    v_pk_add_f32 v[78:79], v[78:79], s[72:73]
    v_rcp_f32 v64, v64
    v_rcp_f32 v65, v65
    v_rcp_f32 v66, v66
    v_rcp_f32 v67, v67
    v_rcp_f32 v68, v68
    v_rcp_f32 v69, v69
    v_rcp_f32 v70, v70
    v_rcp_f32 v71, v71
    v_rcp_f32 v72, v72
    v_rcp_f32 v73, v73
    v_rcp_f32 v74, v74
    v_rcp_f32 v75, v75
    v_rcp_f32 v76, v76
    v_rcp_f32 v77, v77
    v_rcp_f32 v78, v78
    v_rcp_f32 v79, v79
    v_pk_mul_f32 v[48:49], v[48:49], v[64:65]
    v_pk_mul_f32 v[50:51], v[50:51], v[66:67]
    v_pk_mul_f32 v[52:53], v[52:53], v[68:69]
    v_pk_mul_f32 v[54:55], v[54:55], v[70:71]
    v_pk_mul_f32 v[56:57], v[56:57], v[72:73]
    v_pk_mul_f32 v[58:59], v[58:59], v[74:75]
    v_pk_mul_f32 v[60:61], v[60:61], v[76:77]
    v_pk_mul_f32 v[62:63], v[62:63], v[78:79]
    v_mov_b32 v16, v3
    v_mov_b32 v17, v3
    v_mov_b32 v18, v3
    v_mov_b32 v19, v3
    v_mov_b32 v20, v3
    v_mov_b32 v21, v3
    v_mov_b32 v22, v3
    v_mov_b32 v23, v3
    v_and_b32 v8, 7, v0
    v_lshlrev_b32 v13, 3, v8
    v_lshlrev_b32 v8, 2, v8
    v_lshlrev_b32 v9, 7, v0
    s_lshl_b32 s41, s64, 5
    s_add_u32 s41, s41, 131072
    s_lshl_b32 s40, s16, 7
    s_add_u32 s40, s40, 4096
    s_lshl_b32 s42, s75, 5
    s_sub_u32 s42, 2016, s42
    s_cmp_ge_u32 s17, 20
    s_cbranch_scc1 TO_10
    s_mov_b32 s57, 0
LW_12:
    ds_read_b32 v11, v92 offset:44
    s_waitcnt lgkmcnt(0)
    v_cmp_gt_u32 vcc, 4, v11
    s_cbranch_vccz LW_12_x
    s_sleep 4
    s_add_u32 s57, s57, 1
    s_cmp_lt_u32 s57, 100000
    s_cbranch_scc1 LW_12
LW_12_x:
    s_mov_b32 s57, 0
TI_13:
    buffer_load_dwordx2 v[10:11], v13, s[60:63], s40 offen sc1
    s_waitcnt vmcnt(0)
    v_cmp_ne_u32 vcc, s56, v11
    s_cbranch_vccz TI_13_x
    s_sleep 2
    s_add_u32 s57, s57, 1
    s_cmp_lt_u32 s57, 100000
    s_cbranch_scc1 TI_13
TI_13_x:
    s_branch TE_11
TO_10:
    s_mov_b32 s57, 0
LW_14:
    ds_read_b32 v11, v92 offset:48
    s_waitcnt lgkmcnt(0)
    v_cmp_gt_u32 vcc, 1, v11
    s_cbranch_vccz LW_14_x
    s_sleep 4
    s_add_u32 s57, s57, 1
    s_cmp_lt_u32 s57, 100000
    s_cbranch_scc1 LW_14
LW_14_x:
    ds_read_b32 v10, v8 offset:61632
    s_waitcnt lgkmcnt(0)
TE_11:
    s_mov_b64 exec, 0xff
    buffer_load_dword v12, v9, s[60:63], s41 offen sc1
    s_mov_b64 exec, -1
    v_and_b32 v10, 0x7ff, v10
    v_subrev_u32 v11, s42, v10
    v_cmp_gt_u32 vcc, 32, v11
    s_cbranch_vccz TM_15
    v_sub_u32 v10, 2047, v10
    v_mov_b32 v7, 0
    v_readlane_b32 s44, v10, 0
    v_readlane_b32 s45, v10, 1
    v_readlane_b32 s46, v10, 2
    v_readlane_b32 s47, v10, 3
    v_readlane_b32 s48, v10, 4
    v_readlane_b32 s49, v10, 5
    v_readlane_b32 s50, v10, 6
    v_readlane_b32 s51, v10, 7
    v_sub_u32 v8, s44, v2
    v_cmp_gt_u32 vcc, 8, v8
    v_lshlrev_b32 v8, v8, 1
    s_nop 0
    v_cndmask_b32 v8, 0, v8, vcc
    v_or_b32 v7, v7, v8
    v_sub_u32 v8, s45, v2
    v_cmp_gt_u32 vcc, 8, v8
    v_lshlrev_b32 v8, v8, 1
    s_nop 0
    v_cndmask_b32 v8, 0, v8, vcc
    v_or_b32 v7, v7, v8
    v_sub_u32 v8, s46, v2
    v_cmp_gt_u32 vcc, 8, v8
    v_lshlrev_b32 v8, v8, 1
    s_nop 0
    v_cndmask_b32 v8, 0, v8, vcc
    v_or_b32 v7, v7, v8
    v_sub_u32 v8, s47, v2
    v_cmp_gt_u32 vcc, 8, v8
    v_lshlrev_b32 v8, v8, 1
    s_nop 0
    v_cndmask_b32 v8, 0, v8, vcc
    v_or_b32 v7, v7, v8
    v_sub_u32 v8, s48, v2
    v_cmp_gt_u32 vcc, 8, v8
    v_lshlrev_b32 v8, v8, 1
    s_nop 0
    v_cndmask_b32 v8, 0, v8, vcc
    v_or_b32 v7, v7, v8
    v_sub_u32 v8, s49, v2
    v_cmp_gt_u32 vcc, 8, v8
    v_lshlrev_b32 v8, v8, 1
    s_nop 0
    v_cndmask_b32 v8, 0, v8, vcc
    v_or_b32 v7, v7, v8
    v_sub_u32 v8, s50, v2
    v_cmp_gt_u32 vcc, 8, v8
    v_lshlrev_b32 v8, v8, 1
    s_nop 0
    v_cndmask_b32 v8, 0, v8, vcc
    v_or_b32 v7, v7, v8
    v_sub_u32 v8, s51, v2
    v_cmp_gt_u32 vcc, 8, v8
    v_lshlrev_b32 v8, v8, 1
    s_nop 0
    v_cndmask_b32 v8, 0, v8, vcc
    v_or_b32 v7, v7, v8
    v_bfe_i32 v16, v7, 0, 1
    v_and_b32 v16, 0x80000000, v16
    v_or_b32 v16, v16, v3
    v_bfe_i32 v17, v7, 1, 1
    v_and_b32 v17, 0x80000000, v17
    v_or_b32 v17, v17, v3
    v_bfe_i32 v18, v7, 2, 1
    v_and_b32 v18, 0x80000000, v18
    v_or_b32 v18, v18, v3
    v_bfe_i32 v19, v7, 3, 1
    v_and_b32 v19, 0x80000000, v19
    v_or_b32 v19, v19, v3
    v_bfe_i32 v20, v7, 4, 1
    v_and_b32 v20, 0x80000000, v20
    v_or_b32 v20, v20, v3
    v_bfe_i32 v21, v7, 5, 1
    v_and_b32 v21, 0x80000000, v21
    v_or_b32 v21, v21, v3
    v_bfe_i32 v22, v7, 6, 1
    v_and_b32 v22, 0x80000000, v22
    v_or_b32 v22, v22, v3
    v_bfe_i32 v23, v7, 7, 1
    v_and_b32 v23, 0x80000000, v23
    v_or_b32 v23, v23, v3
TM_15:
    s_mov_b64 exec, 0xff
    s_waitcnt vmcnt(0)
    v_cmp_ne_u32 vcc, s56, v12
    s_and_b64 exec, exec, vcc
    s_cbranch_execz TF0_16
    s_mov_b32 s57, 0
TF_17:
    buffer_load_dword v12, v9, s[60:63], s41 offen sc1
    s_waitcnt vmcnt(0)
    v_cmp_ne_u32 vcc, s56, v12
    s_and_b64 exec, exec, vcc
    s_cbranch_execz TF_17_x
    s_sleep 2
    s_add_u32 s57, s57, 1
    s_cmp_lt_u32 s57, 100000
    s_cbranch_scc1 TF_17
TF_17_x:
    s_mov_b64 exec, -1
TF0_16:
    s_mov_b64 exec, -1
    s_mov_b32 exec_lo, 0
    s_mov_b32 exec_hi, 0x80000000
    s_mov_b32 s57, 0
TH_18:
    buffer_load_dword v9, v6, s[60:63], s68 offen offset:12 sc1
    s_waitcnt vmcnt(0)
    v_cmp_eq_u32 vcc, -1, v9
    s_and_b64 exec, exec, vcc
    s_cbranch_execz TH_18_x
    s_sleep 2
    s_add_u32 s57, s57, 1
    s_cmp_lt_u32 s57, 100000
    s_cbranch_scc1 TH_18
TH_18_x:
    s_mov_b64 exec, -1
    s_mov_b32 s57, 0
TY_19:
    buffer_load_dwordx4 v[80:83], v6, s[60:63], s67 offen sc1
    buffer_load_dwordx4 v[84:87], v6, s[60:63], s68 offen sc1
    s_waitcnt vmcnt(0)
    v_max3_u32 v8, v80, v81, v82
    v_max3_u32 v8, v8, v83, v84
    v_max3_u32 v8, v8, v85, v86
    v_max_u32 v8, v8, v87
    v_cmp_eq_u32 vcc, -1, v8
    s_and_b64 exec, exec, vcc
    s_cbranch_execz TY_19_x
    s_sleep 1
    s_add_u32 s57, s57, 1
    s_cmp_lt_u32 s57, 100000
    s_cbranch_scc1 TY_19
TY_19_x:
    s_mov_b64 exec, -1
    ds_write_b128 v91, v[80:83]
    ds_write_b128 v91, v[84:87] offset:1152
    ds_read_b128 v[80:83], v94
    ds_read_b128 v[84:87], v94 offset:64
    s_waitcnt lgkmcnt(0)
    v_lshlrev_b32 v64, 16, v80
    v_lshlrev_b32 v65, 16, v84
    v_pk_fma_f32 v[64:65], v[64:65], v[48:49], v[32:33]
    v_cvt_pk_bf16_f32 v8, v64, v65
    buffer_store_dword v8, v16, s[36:39], 0 offen offset:0
    v_and_b32 v66, 0xffff0000, v80
    v_and_b32 v67, 0xffff0000, v84
    v_pk_fma_f32 v[66:67], v[66:67], v[50:51], v[34:35]
    v_cvt_pk_bf16_f32 v9, v66, v67
    buffer_store_dword v9, v17, s[36:39], 0 offen offset:1280
    v_lshlrev_b32 v68, 16, v81
    v_lshlrev_b32 v69, 16, v85
    v_pk_fma_f32 v[68:69], v[68:69], v[52:53], v[36:37]
    v_cvt_pk_bf16_f32 v10, v68, v69
    buffer_store_dword v10, v18, s[36:39], 0 offen offset:2560
    v_and_b32 v70, 0xffff0000, v81
    v_and_b32 v71, 0xffff0000, v85
    v_pk_fma_f32 v[70:71], v[70:71], v[54:55], v[38:39]
    v_cvt_pk_bf16_f32 v11, v70, v71
    buffer_store_dword v11, v19, s[36:39], 0 offen offset:3840
    v_lshlrev_b32 v72, 16, v82
    v_lshlrev_b32 v73, 16, v86
    v_pk_fma_f32 v[72:73], v[72:73], v[56:57], v[40:41]
    v_cvt_pk_bf16_f32 v12, v72, v73
    buffer_store_dword v12, v20, s[36:39], s18 offen offset:0
    v_and_b32 v74, 0xffff0000, v82
    v_and_b32 v75, 0xffff0000, v86
    v_pk_fma_f32 v[74:75], v[74:75], v[58:59], v[42:43]
    v_cvt_pk_bf16_f32 v13, v74, v75
    buffer_store_dword v13, v21, s[36:39], s18 offen offset:1280
    v_lshlrev_b32 v76, 16, v83
    v_lshlrev_b32 v77, 16, v87
    v_pk_fma_f32 v[76:77], v[76:77], v[60:61], v[44:45]
    v_cvt_pk_bf16_f32 v14, v76, v77
    buffer_store_dword v14, v22, s[36:39], s18 offen offset:2560
    v_and_b32 v78, 0xffff0000, v83
    v_and_b32 v79, 0xffff0000, v87
    v_pk_fma_f32 v[78:79], v[78:79], v[62:63], v[46:47]
    v_cvt_pk_bf16_f32 v15, v78, v79
    buffer_store_dword v15, v23, s[36:39], s18 offen offset:3840
    s_endpgm
K_L:
    ds_write_b128 v11, v[12:15]
    ds_write_b128 v11, v[12:15] offset:16
    ds_write_b128 v11, v[12:15] offset:32
    ds_write_b128 v11, v[12:15] offset:48
    s_mov_b32 s60, s54
    s_mov_b32 s61, s55
    s_mov_b32 s62, 16777216
    s_mov_b32 s63, 0x20000
    s_waitcnt lgkmcnt(0)
    s_barrier
    s_load_dword s56, s[54:55], 0
    v_mov_b32 v18, 1
    s_mov_b32 s58, 0x3f803f80
    s_mov_b32 s41, 986500301
    s_waitcnt vmcnt(3)
    v_dot2_f32_bf16 v120, v72, s58, 0
    v_dot2_f32_bf16 v120, v73, s58, v120
    v_dot2_f32_bf16 v120, v74, s58, v120
    v_dot2_f32_bf16 v120, v75, s58, v120
    v_dot2_f32_bf16 v120, v76, s58, v120
    v_dot2_f32_bf16 v120, v77, s58, v120
    v_dot2_f32_bf16 v120, v78, s58, v120
    v_dot2_f32_bf16 v120, v79, s58, v120
    v_dot2_f32_bf16 v120, v80, s58, v120
    v_dot2_f32_bf16 v120, v81, s58, v120
    v_lshlrev_b32 v96, 16, v72
    v_and_b32 v97, 0xffff0000, v72
    v_lshlrev_b32 v98, 16, v73
    v_and_b32 v99, 0xffff0000, v73
    v_lshlrev_b32 v100, 16, v74
    v_and_b32 v101, 0xffff0000, v74
    v_add_f32_dpp v120, v120, v120 row_ror:8 row_mask:0xf bank_mask:0xf
    v_lshlrev_b32 v102, 16, v75
    v_and_b32 v103, 0xffff0000, v75
    v_add_f32_dpp v120, v120, v120 row_ror:4 row_mask:0xf bank_mask:0xf
    v_lshlrev_b32 v104, 16, v76
    v_and_b32 v105, 0xffff0000, v76
    v_add_f32_dpp v120, v120, v120 row_ror:2 row_mask:0xf bank_mask:0xf
    v_lshlrev_b32 v106, 16, v77
    v_and_b32 v107, 0xffff0000, v77
    v_add_f32_dpp v120, v120, v120 row_ror:1 row_mask:0xf bank_mask:0xf
    v_lshlrev_b32 v108, 16, v78
    v_and_b32 v109, 0xffff0000, v78
    v_mov_b32 v121, v120
    v_lshlrev_b32 v110, 16, v79
    v_and_b32 v111, 0xffff0000, v79
    v_permlane16_swap_b32 v120, v121
    v_lshlrev_b32 v112, 16, v80
    v_and_b32 v113, 0xffff0000, v80
    v_add_f32 v120, v120, v121
    v_lshlrev_b32 v114, 16, v81
    v_and_b32 v115, 0xffff0000, v81
    v_mul_f32 v120, s41, v120
    v_cvt_pk_bf16_f32 v122, v120, v120
    v_and_b32 v122, 0xffff0000, v122
    v_sub_f32 v120, v120, v122
    v_pk_add_f32 v[96:97], v[96:97], v[122:123] op_sel_hi:[1,0] neg_lo:[0,1] neg_hi:[0,1]
    v_pk_add_f32 v[98:99], v[98:99], v[122:123] op_sel_hi:[1,0] neg_lo:[0,1] neg_hi:[0,1]
    v_pk_add_f32 v[100:101], v[100:101], v[122:123] op_sel_hi:[1,0] neg_lo:[0,1] neg_hi:[0,1]
    v_pk_add_f32 v[102:103], v[102:103], v[122:123] op_sel_hi:[1,0] neg_lo:[0,1] neg_hi:[0,1]
    v_pk_add_f32 v[104:105], v[104:105], v[122:123] op_sel_hi:[1,0] neg_lo:[0,1] neg_hi:[0,1]
    v_pk_add_f32 v[106:107], v[106:107], v[122:123] op_sel_hi:[1,0] neg_lo:[0,1] neg_hi:[0,1]
    v_pk_add_f32 v[108:109], v[108:109], v[122:123] op_sel_hi:[1,0] neg_lo:[0,1] neg_hi:[0,1]
    v_pk_add_f32 v[110:111], v[110:111], v[122:123] op_sel_hi:[1,0] neg_lo:[0,1] neg_hi:[0,1]
    v_pk_add_f32 v[112:113], v[112:113], v[122:123] op_sel_hi:[1,0] neg_lo:[0,1] neg_hi:[0,1]
    v_pk_add_f32 v[114:115], v[114:115], v[122:123] op_sel_hi:[1,0] neg_lo:[0,1] neg_hi:[0,1]
    v_pk_mul_f32 v[124:125], v[96:97], v[96:97]
    v_pk_fma_f32 v[124:125], v[98:99], v[98:99], v[124:125]
    v_pk_fma_f32 v[124:125], v[100:101], v[100:101], v[124:125]
    v_pk_fma_f32 v[124:125], v[102:103], v[102:103], v[124:125]
    v_pk_fma_f32 v[124:125], v[104:105], v[104:105], v[124:125]
    v_pk_fma_f32 v[124:125], v[106:107], v[106:107], v[124:125]
    v_pk_fma_f32 v[124:125], v[108:109], v[108:109], v[124:125]
    v_pk_fma_f32 v[124:125], v[110:111], v[110:111], v[124:125]
    v_pk_fma_f32 v[124:125], v[112:113], v[112:113], v[124:125]
    v_pk_fma_f32 v[124:125], v[114:115], v[114:115], v[124:125]
    v_add_f32 v124, v124, v125
    v_cvt_pk_bf16_f32 v72, v96, v97
    v_cvt_pk_bf16_f32 v73, v98, v99
    v_add_f32_dpp v124, v124, v124 row_ror:8 row_mask:0xf bank_mask:0xf
    v_cvt_pk_bf16_f32 v74, v100, v101
    v_cvt_pk_bf16_f32 v75, v102, v103
    v_add_f32_dpp v124, v124, v124 row_ror:4 row_mask:0xf bank_mask:0xf
    v_cvt_pk_bf16_f32 v76, v104, v105
    v_cvt_pk_bf16_f32 v77, v106, v107
    v_add_f32_dpp v124, v124, v124 row_ror:2 row_mask:0xf bank_mask:0xf
    v_cvt_pk_bf16_f32 v78, v108, v109
    v_cvt_pk_bf16_f32 v79, v110, v111
    v_add_f32_dpp v124, v124, v124 row_ror:1 row_mask:0xf bank_mask:0xf
    v_cvt_pk_bf16_f32 v80, v112, v113
    v_cvt_pk_bf16_f32 v81, v114, v115
    v_mov_b32 v121, v124
    v_lshlrev_b32 v96, 16, v72
    v_and_b32 v97, 0xffff0000, v72
    v_permlane16_swap_b32 v124, v121
    v_add_f32 v124, v124, v121
    v_mul_f32 v124, s41, v124
    v_fma_f32 v124, -v120, v120, v124
    v_max_f32 v124, 0, v124
    v_cvt_pk_bf16_f32 v124, v124, v124
    v_and_b32 v124, 0xffff0000, v124
    v_add_f32 v124, 925353388, v124
    v_cvt_pk_bf16_f32 v124, v124, v124
    v_and_b32 v124, 0xffff0000, v124
    v_sqrt_f32 v124, v124
    v_lshlrev_b32 v98, 16, v73
    v_and_b32 v99, 0xffff0000, v73
    v_cvt_pk_bf16_f32 v124, v124, v124
    v_and_b32 v124, 0xffff0000, v124
    v_rcp_f32 v126, v124
    v_lshlrev_b32 v100, 16, v74
    v_and_b32 v101, 0xffff0000, v74
    v_lshlrev_b32 v102, 16, v75
    v_and_b32 v103, 0xffff0000, v75
    v_lshlrev_b32 v104, 16, v76
    v_and_b32 v105, 0xffff0000, v76
    v_lshlrev_b32 v106, 16, v77
    v_and_b32 v107, 0xffff0000, v77
    v_lshlrev_b32 v108, 16, v78
    v_and_b32 v109, 0xffff0000, v78
    v_lshlrev_b32 v110, 16, v79
    v_and_b32 v111, 0xffff0000, v79
    v_lshlrev_b32 v112, 16, v80
    v_and_b32 v113, 0xffff0000, v80
    v_lshlrev_b32 v114, 16, v81
    v_and_b32 v115, 0xffff0000, v81
    v_pk_mul_f32 v[96:97], v[96:97], v[126:127] op_sel_hi:[1,0]
    v_pk_mul_f32 v[98:99], v[98:99], v[126:127] op_sel_hi:[1,0]
    v_pk_mul_f32 v[100:101], v[100:101], v[126:127] op_sel_hi:[1,0]
    v_pk_mul_f32 v[102:103], v[102:103], v[126:127] op_sel_hi:[1,0]
    v_pk_mul_f32 v[104:105], v[104:105], v[126:127] op_sel_hi:[1,0]
    v_pk_mul_f32 v[106:107], v[106:107], v[126:127] op_sel_hi:[1,0]
    v_pk_mul_f32 v[108:109], v[108:109], v[126:127] op_sel_hi:[1,0]
    v_pk_mul_f32 v[110:111], v[110:111], v[126:127] op_sel_hi:[1,0]
    v_pk_mul_f32 v[112:113], v[112:113], v[126:127] op_sel_hi:[1,0]
    v_pk_mul_f32 v[114:115], v[114:115], v[126:127] op_sel_hi:[1,0]
    v_cvt_pk_bf16_f32 v72, v96, v97
    v_cvt_pk_bf16_f32 v73, v98, v99
    v_cvt_pk_bf16_f32 v74, v100, v101
    v_cvt_pk_bf16_f32 v75, v102, v103
    v_cvt_pk_bf16_f32 v76, v104, v105
    v_cvt_pk_bf16_f32 v77, v106, v107
    v_cvt_pk_bf16_f32 v78, v108, v109
    v_cvt_pk_bf16_f32 v79, v110, v111
    v_cvt_pk_bf16_f32 v80, v112, v113
    v_cvt_pk_bf16_f32 v81, v114, v115
    s_waitcnt vmcnt(0) lgkmcnt(0)
    s_add_u32 s56, s56, 1
    v_mov_b32 v17, s56
    s_mov_b64 exec, 1
    ds_write_b32 v11, v17 offset:16
    ds_write_b32 v11, v18 offset:12
    s_mov_b64 exec, -1
    v_dot2_f32_bf16 v126, v72, v84, 0
    v_dot2_f32_bf16 v126, v73, v85, v126
    v_dot2_f32_bf16 v126, v74, v86, v126
    v_dot2_f32_bf16 v126, v75, v87, v126
    v_dot2_f32_bf16 v126, v76, v88, v126
    v_dot2_f32_bf16 v126, v77, v89, v126
    v_dot2_f32_bf16 v126, v78, v90, v126
    v_dot2_f32_bf16 v126, v79, v91, v126
    v_dot2_f32_bf16 v126, v80, v92, v126
    v_dot2_f32_bf16 v126, v81, v93, v126
    v_lshrrev_b32 v122, 16, v122
    v_or_b32 v96, v122, v124
    v_and_b32 v100, 7, v2
    v_add_f32_dpp v126, v126, v126 row_ror:8 row_mask:0xf bank_mask:0xf
    v_lshlrev_b32 v100, 3, v100
    v_mov_b32 v97, s56
    v_add_f32_dpp v126, v126, v126 row_ror:4 row_mask:0xf bank_mask:0xf
    v_mov_b32 v99, s56
    v_lshlrev_b32 v102, 4, v1
    v_add_f32_dpp v126, v126, v126 row_ror:2 row_mask:0xf bank_mask:0xf
    v_sub_u32 v127, 2047, v2
    s_lshl_b32 s40, s76, 7
    v_add_f32_dpp v126, v126, v126 row_ror:1 row_mask:0xf bank_mask:0xf
    s_add_u32 s40, s40, 65536
    s_nop 0
    v_mov_b32 v121, v126
    s_nop 1
    v_permlane16_swap_b32 v126, v121
    v_add_f32 v126, v126, v121
    v_add_f32 v126, 0, v126
    v_cvt_pk_bf16_f32 v126, v126, v126
    v_ashrrev_i32 v121, 31, v126
    v_or_b32 v121, 0x80000000, v121
    v_xor_b32 v126, v126, v121
    v_and_b32 v126, 0xffff0000, v126
    v_or_b32 v98, v126, v127
    s_mov_b32 exec_lo, 1
    s_mov_b32 exec_hi, 1
    ds_write_b64 v100, v[98:99] offset:61760
    ds_write_b64 v100, v[96:97] offset:61824
    s_mov_b32 exec_hi, 0
    ds_add_rtn_u32 v18, v11, v18 offset:20
    s_mov_b64 exec, 0xff
    ds_read_b128 v[108:111], v102 offset:61760
    s_waitcnt lgkmcnt(0)
    v_readfirstlane_b32 s41, v18
    s_cmp_eq_u32 s41, 3
    s_cselect_b32 s40, s40, 0x80000000
    buffer_store_dwordx4 v[108:111], v102, s[60:63], s40 offen sc1
    s_mov_b64 exec, -1
    s_cmp_ge_u32 s17, 20
    s_cbranch_scc1 K_FFN
    s_mul_i32 s18, s16, 80
    s_lshl_b32 s19, s17, 2
    s_add_u32 s19, s19, s3
    s_add_u32 s64, s18, s19
    s_lshl_b32 s65, s64, 12
    v_lshlrev_b32 v8, 4, v1
    s_mov_b32 s28, s12
    s_mov_b32 s29, s13
    s_mov_b32 s30, 2621440
    s_mov_b32 s31, 0x20000
    s_mov_b32 s57, 0
LW_20:
    ds_read_b32 v16, v11 offset:24
    s_waitcnt lgkmcnt(0)
    v_cmp_gt_u32 vcc, 5, v16
    s_cbranch_vccz LW_20_x
    s_add_u32 s57, s57, 1
    s_cmp_lt_u32 s57, 100000
    s_cbranch_scc1 LW_20
LW_20_x:
    buffer_load_dwordx4 v[40:43], v8, s[28:31], s65 offen offset:0
    buffer_load_dwordx4 v[44:47], v8, s[28:31], s65 offen offset:1024
    buffer_load_dwordx4 v[48:51], v8, s[28:31], s65 offen offset:2048
    buffer_load_dwordx4 v[52:55], v8, s[28:31], s65 offen offset:3072
    s_mul_i32 s66, s64, 4224
    s_mul_i32 s67, s3, 12864
    s_lshl_b32 s40, s64, 1
    s_and_b32 s40, s40, 0xfffffffc
    s_add_u32 s14, s14, s40
    s_addc_u32 s15, s15, 0
    s_load_dword s68, s[14:15], 0
    v_add_u32 v9, s67, v8
    s_mov_b64 exec, 0x3fffffff
    ds_write_b128 v9, v[12:15] offset:12384
    s_mov_b64 exec, 3
    ds_write_b128 v9, v[12:15] offset:0
    ds_write_b128 v9, v[12:15] offset:4160
    s_mov_b64 exec, -1
    v_mov_b32 v143, 61440
    v_and_b32 v10, 15, v1
    v_lshrrev_b32 v11, 4, v1
    v_and_b32 v16, 1, v10
    v_add_u32 v136, v10, v16
    v_lshlrev_b32 v136, 1, v136
    v_lshl_add_u32 v136, v11, 4, v136
    v_xor_b32 v16, 1, v16
    v_mul_u32_u24 v16, 4160, v16
    v_add3_u32 v136, v136, v16, s67
    v_add_u32 v137, 1024, v136
    v_add_u32 v138, 2048, v136
    v_add_u32 v139, 3072, v136
    v_lshlrev_b32 v140, 5, v10
    v_sub_u32 v140, 8768, v140
    v_lshl_add_u32 v140, v11, 4, v140
    v_add_u32 v140, s67, v140
    v_lshlrev_b32 v141, 5, v10
    v_lshl_add_u32 v142, v11, 3, v141
    v_sub_u32 v142, 8792, v142
    v_add_u32 v142, s67, v142
    v_and_b32 v16, 1, v11
    v_lshl_add_u32 v141, v16, 9, v141
    v_lshrrev_b32 v16, 1, v11
    v_lshl_add_u32 v141, v16, 4, v141
    v_mov_b32 v12, 1
    s_lshr_b32 s43, s64, 5
    s_lshl_b32 s43, s43, 13
    s_add_u32 s43, s43, 524288
    v_lshlrev_b32 v19, 7, v1
    s_waitcnt vmcnt(0)
    v_mov_b32_dpp v56, v40 wave_shl:1 row_mask:0xf bank_mask:0xf
    v_mov_b32_dpp v57, v44 wave_shl:1 row_mask:0xf bank_mask:0xf
    v_mov_b32_dpp v58, v48 wave_shl:1 row_mask:0xf bank_mask:0xf
    v_mov_b32_dpp v59, v52 wave_shl:1 row_mask:0xf bank_mask:0xf
    v_readlane_b32 s40, v44, 0
    v_readlane_b32 s41, v48, 0
    v_readlane_b32 s42, v52, 0
    v_writelane_b32 v56, s40, 63
    v_writelane_b32 v57, s41, 63
    v_writelane_b32 v58, s42, 63
    ds_write_b128 v9, v[40:43] offset:32
    v_alignbyte_b32 v20, v41, v40, 2
    v_alignbyte_b32 v21, v42, v41, 2
    v_alignbyte_b32 v22, v43, v42, 2
    v_alignbyte_b32 v23, v56, v43, 2
    ds_write_b128 v9, v[20:23] offset:4192
    ds_write_b128 v9, v[44:47] offset:1056
    v_alignbyte_b32 v24, v45, v44, 2
    v_alignbyte_b32 v25, v46, v45, 2
    v_alignbyte_b32 v26, v47, v46, 2
    v_alignbyte_b32 v27, v57, v47, 2
    ds_write_b128 v9, v[24:27] offset:5216
    ds_write_b128 v9, v[48:51] offset:2080
    v_alignbyte_b32 v28, v49, v48, 2
    v_alignbyte_b32 v29, v50, v49, 2
    v_alignbyte_b32 v30, v51, v50, 2
    v_alignbyte_b32 v31, v58, v51, 2
    ds_write_b128 v9, v[28:31] offset:6240
    ds_write_b128 v9, v[52:55] offset:3104
    v_alignbyte_b32 v32, v53, v52, 2
    v_alignbyte_b32 v33, v54, v53, 2
    v_alignbyte_b32 v34, v55, v54, 2
    v_alignbyte_b32 v35, v59, v55, 2
    ds_write_b128 v9, v[32:35] offset:7264
    v_lshlrev_b32 v16, 16, v40
    s_mov_b64 exec, 1
    ds_write_b32 v9, v16 offset:4188
    s_mov_b64 exec, -1
    ds_read2_b32 v[68:69], v139 offset0:128 offset1:129
    ds_read2_b32 v[70:71], v139 offset0:130 offset1:131
    ds_read2_b32 v[64:65], v139 offset0:0 offset1:1
    ds_read2_b32 v[66:67], v139 offset0:2 offset1:3
    ds_read2_b32 v[60:61], v138 offset0:128 offset1:129
    ds_read2_b32 v[62:63], v138 offset0:130 offset1:131
    ds_read2_b32 v[56:57], v138 offset0:0 offset1:1
    ds_read2_b32 v[58:59], v138 offset0:2 offset1:3
    ds_read2_b32 v[52:53], v137 offset0:128 offset1:129
    ds_read2_b32 v[54:55], v137 offset0:130 offset1:131
    ds_read2_b32 v[48:49], v137 offset0:0 offset1:1
    ds_read2_b32 v[50:51], v137 offset0:2 offset1:3
    ds_read2_b32 v[44:45], v136 offset0:128 offset1:129
    ds_read2_b32 v[46:47], v136 offset0:130 offset1:131
    ds_read2_b32 v[40:41], v136 offset0:0 offset1:1
    ds_read2_b32 v[42:43], v136 offset0:2 offset1:3
    s_add_u32 s40, s66, 1048576
    s_add_u32 m0, s67, 8288
    s_cmp_lg_u32 s3, 0
    s_cbranch_scc1 CO_21
    s_mov_b32 s57, 0
LW_23:
    ds_read_b32 v17, v143 offset:32
    s_waitcnt lgkmcnt(0)
    v_cmp_gt_u32 vcc, 5, v17
    s_cbranch_vccz LW_23_x
    s_add_u32 s57, s57, 1
    s_cmp_lt_u32 s57, 100000
    s_cbranch_scc1 LW_23
LW_23_x:
    s_mov_b32 s57, 0
CF_24:
    buffer_load_dword v17, v19, s[60:63], s43 offen sc1
    s_waitcnt vmcnt(0)
    v_cmp_ne_u32 vcc, s56, v17
    s_and_b64 exec, exec, vcc
    s_cbranch_execz CF_24_x
    s_sleep 1
    s_add_u32 s57, s57, 1
    s_cmp_lt_u32 s57, 100000
    s_cbranch_scc1 CF_24
CF_24_x:
    s_mov_b64 exec, -1
    ds_write_b32 v143, v12 offset:36
    s_branch CE_22
CO_21:
    s_mov_b32 s57, 0
LW_25:
    ds_read_b32 v17, v143 offset:36
    s_waitcnt lgkmcnt(0)
    v_cmp_gt_u32 vcc, 1, v17
    s_cbranch_vccz LW_25_x
    s_add_u32 s57, s57, 1
    s_cmp_lt_u32 s57, 100000
    s_cbranch_scc1 LW_25
LW_25_x:
CE_22:
    buffer_load_dwordx4 v8, s[60:63], s40 offen offset:3072 sc1 lds
    buffer_load_dwordx4 v8, s[60:63], s40 offen offset:2048 sc1 lds
    buffer_load_dwordx4 v8, s[60:63], s40 offen offset:1024 sc1 lds
    buffer_load_dwordx4 v8, s[60:63], s40 offen offset:0 sc1 lds
    s_setprio 1
    s_lshr_b32 s42, s64, 2
    s_lshl_b32 s42, s42, 7
    s_add_u32 s42, s42, 131072
    s_lshr_b32 s43, s64, 5
    s_lshl_b32 s43, s43, 10
    s_add_u32 s43, s43, 262144
    s_and_b32 s41, s64, 31
    s_cmp_eq_u32 s41, 31
    s_cselect_b32 s43, s43, 0x80000000
    v_mov_b32 v144, 1
    v_mov_b32 v145, s56
    v_mov_b32 v146, 0
    v_mov_b32 v12, -1
    v_mov_b32 v13, -1
    v_mov_b32 v14, -1
    v_mov_b32 v15, -1
    s_and_b32 s41, s64, 1
    s_lshl_b32 s41, s41, 4
    s_waitcnt lgkmcnt(0)
    s_lshr_b32 s68, s68, s41
    s_and_b32 s68, s68, 0xffff
    s_lshl_b32 s69, s68, 16
    s_add_u32 s40, s66, 4194304
    s_waitcnt vmcnt(0)
    v_mov_b32 v147, v8
    v_mov_b32 v148, v19
    ds_read_b128 v[72:75], v140 offset:3584
    ds_read_b128 v[76:79], v140 offset:3072
    ds_read_b128 v[80:83], v140 offset:2560
    ds_read_b128 v[84:87], v140 offset:2048
    ds_read_b128 v[88:91], v140 offset:1536
    ds_read_b128 v[92:95], v140 offset:1024
    ds_read_b128 v[96:99], v140 offset:512
    ds_read_b128 v[100:103], v140 offset:0
    s_waitcnt lgkmcnt(7)
    v_mfma_f32_16x16x32_bf16 v[36:39], v[68:71], v[72:75], 0
    v_mfma_f32_16x16x32_bf16 v[32:35], v[64:67], v[72:75], 0
    ds_read2_b32 v[68:69], v139 offset0:144 offset1:145
    s_waitcnt lgkmcnt(7)
    v_mfma_f32_16x16x32_bf16 v[36:39], v[64:67], v[76:79], v[36:39]
    ds_read2_b32 v[70:71], v139 offset0:146 offset1:147
    v_mfma_f32_16x16x32_bf16 v[28:31], v[60:63], v[72:75], 0
    ds_read2_b32 v[64:65], v139 offset0:16 offset1:17
    v_mfma_f32_16x16x32_bf16 v[32:35], v[60:63], v[76:79], v[32:35]
    ds_read2_b32 v[66:67], v139 offset0:18 offset1:19
    s_waitcnt lgkmcnt(9)
    v_mfma_f32_16x16x32_bf16 v[36:39], v[60:63], v[80:83], v[36:39]
    v_mfma_f32_16x16x32_bf16 v[24:27], v[56:59], v[72:75], 0
    ds_read2_b32 v[60:61], v138 offset0:144 offset1:145
    buffer_store_dwordx4 v[12:15], v147, s[60:63], s40 offen offset:0 sc1
    v_mfma_f32_16x16x32_bf16 v[28:31], v[56:59], v[76:79], v[28:31]
    ds_read2_b32 v[62:63], v138 offset0:146 offset1:147
    buffer_store_dwordx4 v[12:15], v147, s[60:63], s40 offen offset:1024 sc1
    v_mfma_f32_16x16x32_bf16 v[32:35], v[56:59], v[80:83], v[32:35]
    buffer_store_dwordx4 v[12:15], v147, s[60:63], s40 offen offset:2048 sc1
    s_waitcnt lgkmcnt(10)
    v_mfma_f32_16x16x32_bf16 v[36:39], v[56:59], v[84:87], v[36:39]
    buffer_store_dwordx4 v[12:15], v147, s[60:63], s40 offen offset:3072 sc1
    ds_read_b128 v[104:107], v140 offset:3648
    v_mfma_f32_16x16x32_bf16 v[20:23], v[52:55], v[72:75], 0
    ds_read2_b32 v[56:57], v138 offset0:16 offset1:17
    v_mfma_f32_16x16x32_bf16 v[24:27], v[52:55], v[76:79], v[24:27]
    ds_read2_b32 v[58:59], v138 offset0:18 offset1:19
    v_mfma_f32_16x16x32_bf16 v[28:31], v[52:55], v[80:83], v[28:31]
    v_mfma_f32_16x16x32_bf16 v[32:35], v[52:55], v[84:87], v[32:35]
    ds_read_b128 v[108:111], v140 offset:3136
    s_waitcnt lgkmcnt(13)
    v_mfma_f32_16x16x32_bf16 v[36:39], v[52:55], v[88:91], v[36:39]
    v_mfma_f32_16x16x32_bf16 v[16:19], v[48:51], v[72:75], 0
    ds_read2_b32 v[52:53], v137 offset0:144 offset1:145
    v_mfma_f32_16x16x32_bf16 v[20:23], v[48:51], v[76:79], v[20:23]
    ds_read2_b32 v[54:55], v137 offset0:146 offset1:147
    v_mfma_f32_16x16x32_bf16 v[24:27], v[48:51], v[80:83], v[24:27]
    v_mfma_f32_16x16x32_bf16 v[28:31], v[48:51], v[84:87], v[28:31]
    ds_read_b128 v[112:115], v140 offset:2624
    v_mfma_f32_16x16x32_bf16 v[32:35], v[48:51], v[88:91], v[32:35]
    s_waitcnt lgkmcnt(15)
    v_mfma_f32_16x16x32_bf16 v[36:39], v[48:51], v[92:95], v[36:39]
    ds_read_b128 v[116:119], v140 offset:2112
    v_mfma_f32_16x16x32_bf16 v[12:15], v[44:47], v[72:75], 0
    ds_read2_b32 v[48:49], v137 offset0:16 offset1:17
    v_mfma_f32_16x16x32_bf16 v[16:19], v[44:47], v[76:79], v[16:19]
    ds_read2_b32 v[50:51], v137 offset0:18 offset1:19
    v_mfma_f32_16x16x32_bf16 v[20:23], v[44:47], v[80:83], v[20:23]
    v_mfma_f32_16x16x32_bf16 v[24:27], v[44:47], v[84:87], v[24:27]
    ds_read_b128 v[120:123], v140 offset:1600
    v_mfma_f32_16x16x32_bf16 v[28:31], v[44:47], v[88:91], v[28:31]
    v_mfma_f32_16x16x32_bf16 v[32:35], v[44:47], v[92:95], v[32:35]
    ds_read_b128 v[124:127], v140 offset:1088
    s_waitcnt lgkmcnt(15)
    v_mfma_f32_16x16x32_bf16 v[36:39], v[44:47], v[96:99], v[36:39]
    v_mfma_f32_16x16x32_bf16 v[8:11], v[40:43], v[72:75], 0
    ds_read2_b32 v[44:45], v136 offset0:144 offset1:145
    v_mfma_f32_16x16x32_bf16 v[12:15], v[40:43], v[76:79], v[12:15]
    ds_read2_b32 v[46:47], v136 offset0:146 offset1:147
    v_mfma_f32_16x16x32_bf16 v[16:19], v[40:43], v[80:83], v[16:19]
    v_mfma_f32_16x16x32_bf16 v[20:23], v[40:43], v[84:87], v[20:23]
    ds_read_b128 v[128:131], v140 offset:576
    v_mfma_f32_16x16x32_bf16 v[24:27], v[40:43], v[88:91], v[24:27]
    v_mfma_f32_16x16x32_bf16 v[28:31], v[40:43], v[92:95], v[28:31]
    ds_read_b128 v[132:135], v140 offset:64
    v_mfma_f32_16x16x32_bf16 v[32:35], v[40:43], v[96:99], v[32:35]
    v_mfma_f32_16x16x32_bf16 v[36:39], v[40:43], v[100:103], v[36:39]
    s_waitcnt lgkmcnt(15)
    v_mfma_f32_16x16x32_bf16 v[36:39], v[68:71], v[104:107], v[36:39]
    ds_read2_b32 v[40:41], v136 offset0:16 offset1:17
    v_mfma_f32_16x16x32_bf16 v[32:35], v[64:67], v[104:107], v[32:35]
    ds_read2_b32 v[42:43], v136 offset0:18 offset1:19
    s_waitcnt lgkmcnt(14)
    v_mfma_f32_16x16x32_bf16 v[36:39], v[64:67], v[108:111], v[36:39]
    ds_read2_b32 v[68:69], v139 offset0:160 offset1:161
    v_mfma_f32_16x16x32_bf16 v[28:31], v[60:63], v[104:107], v[28:31]
    ds_read2_b32 v[70:71], v139 offset0:162 offset1:163
    v_mfma_f32_16x16x32_bf16 v[32:35], v[60:63], v[108:111], v[32:35]
    ds_read2_b32 v[64:65], v139 offset0:32 offset1:33
    s_waitcnt lgkmcnt(14)
    v_mfma_f32_16x16x32_bf16 v[36:39], v[60:63], v[112:115], v[36:39]
    ds_read2_b32 v[66:67], v139 offset0:34 offset1:35
    v_mfma_f32_16x16x32_bf16 v[24:27], v[56:59], v[104:107], v[24:27]
    ds_read2_b32 v[60:61], v138 offset0:160 offset1:161
    v_mfma_f32_16x16x32_bf16 v[28:31], v[56:59], v[108:111], v[28:31]
    ds_read2_b32 v[62:63], v138 offset0:162 offset1:163
    v_mfma_f32_16x16x32_bf16 v[32:35], v[56:59], v[112:115], v[32:35]
    s_waitcnt lgkmcnt(15)
    v_mfma_f32_16x16x32_bf16 v[36:39], v[56:59], v[116:119], v[36:39]
    ds_read_b128 v[72:75], v140 offset:3712
    v_mfma_f32_16x16x32_bf16 v[20:23], v[52:55], v[104:107], v[20:23]
    ds_read2_b32 v[56:57], v138 offset0:32 offset1:33
    v_mfma_f32_16x16x32_bf16 v[24:27], v[52:55], v[108:111], v[24:27]
    ds_read2_b32 v[58:59], v138 offset0:34 offset1:35
    v_mfma_f32_16x16x32_bf16 v[28:31], v[52:55], v[112:115], v[28:31]
    v_mfma_f32_16x16x32_bf16 v[32:35], v[52:55], v[116:119], v[32:35]
    ds_read_b128 v[76:79], v140 offset:3200
    s_waitcnt lgkmcnt(15)
    v_mfma_f32_16x16x32_bf16 v[36:39], v[52:55], v[120:123], v[36:39]
    v_mfma_f32_16x16x32_bf16 v[16:19], v[48:51], v[104:107], v[16:19]
    ds_read2_b32 v[52:53], v137 offset0:160 offset1:161
    v_mfma_f32_16x16x32_bf16 v[20:23], v[48:51], v[108:111], v[20:23]
    ds_read2_b32 v[54:55], v137 offset0:162 offset1:163
    v_mfma_f32_16x16x32_bf16 v[24:27], v[48:51], v[112:115], v[24:27]
    v_mfma_f32_16x16x32_bf16 v[28:31], v[48:51], v[116:119], v[28:31]
    ds_read_b128 v[80:83], v140 offset:2688
    v_mfma_f32_16x16x32_bf16 v[32:35], v[48:51], v[120:123], v[32:35]
    v_mfma_f32_16x16x32_bf16 v[36:39], v[48:51], v[124:127], v[36:39]
    ds_read_b128 v[84:87], v140 offset:2176
    s_waitcnt lgkmcnt(15)
    v_mfma_f32_16x16x32_bf16 v[12:15], v[44:47], v[104:107], v[12:15]
    ds_read2_b32 v[48:49], v137 offset0:32 offset1:33
    v_mfma_f32_16x16x32_bf16 v[16:19], v[44:47], v[108:111], v[16:19]
    ds_read2_b32 v[50:51], v137 offset0:34 offset1:35
    v_mfma_f32_16x16x32_bf16 v[20:23], v[44:47], v[112:115], v[20:23]
    v_mfma_f32_16x16x32_bf16 v[24:27], v[44:47], v[116:119], v[24:27]
    ds_read_b128 v[88:91], v140 offset:1664
    v_mfma_f32_16x16x32_bf16 v[28:31], v[44:47], v[120:123], v[28:31]
    v_mfma_f32_16x16x32_bf16 v[32:35], v[44:47], v[124:127], v[32:35]
    ds_read_b128 v[92:95], v140 offset:1152
    v_mfma_f32_16x16x32_bf16 v[36:39], v[44:47], v[128:131], v[36:39]
    s_waitcnt lgkmcnt(15)
    v_mfma_f32_16x16x32_bf16 v[8:11], v[40:43], v[104:107], v[8:11]
    ds_read2_b32 v[44:45], v136 offset0:160 offset1:161
    v_mfma_f32_16x16x32_bf16 v[12:15], v[40:43], v[108:111], v[12:15]
    ds_read2_b32 v[46:47], v136 offset0:162 offset1:163
    v_mfma_f32_16x16x32_bf16 v[16:19], v[40:43], v[112:115], v[16:19]
    v_mfma_f32_16x16x32_bf16 v[20:23], v[40:43], v[116:119], v[20:23]
    ds_read_b128 v[96:99], v140 offset:640
    v_mfma_f32_16x16x32_bf16 v[24:27], v[40:43], v[120:123], v[24:27]
    v_mfma_f32_16x16x32_bf16 v[28:31], v[40:43], v[124:127], v[28:31]
    ds_read_b128 v[100:103], v140 offset:128
    v_mfma_f32_16x16x32_bf16 v[32:35], v[40:43], v[128:131], v[32:35]
    v_mfma_f32_16x16x32_bf16 v[36:39], v[40:43], v[132:135], v[36:39]
    s_waitcnt vmcnt(0)
    s_mov_b64 exec, 1
    ds_add_rtn_u32 v144, v143, v144 offset:44
    s_mov_b64 exec, -1
    s_waitcnt lgkmcnt(15)
    v_mfma_f32_16x16x32_bf16 v[36:39], v[68:71], v[72:75], v[36:39]
    ds_read2_b32 v[40:41], v136 offset0:32 offset1:33
    v_mfma_f32_16x16x32_bf16 v[32:35], v[64:67], v[72:75], v[32:35]
    ds_read2_b32 v[42:43], v136 offset0:34 offset1:35
    s_waitcnt lgkmcnt(15)
    v_mfma_f32_16x16x32_bf16 v[36:39], v[64:67], v[76:79], v[36:39]
    ds_read2_b32 v[68:69], v139 offset0:176 offset1:177
    v_mfma_f32_16x16x32_bf16 v[28:31], v[60:63], v[72:75], v[28:31]
    ds_read2_b32 v[70:71], v139 offset0:178 offset1:179
    v_mfma_f32_16x16x32_bf16 v[32:35], v[60:63], v[76:79], v[32:35]
    ds_read2_b32 v[64:65], v139 offset0:48 offset1:49
    s_waitcnt lgkmcnt(15)
    v_mfma_f32_16x16x32_bf16 v[36:39], v[60:63], v[80:83], v[36:39]
    ds_read2_b32 v[66:67], v139 offset0:50 offset1:51
    v_mfma_f32_16x16x32_bf16 v[24:27], v[56:59], v[72:75], v[24:27]
    ds_read2_b32 v[60:61], v138 offset0:176 offset1:177
    v_mfma_f32_16x16x32_bf16 v[28:31], v[56:59], v[76:79], v[28:31]
    ds_read2_b32 v[62:63], v138 offset0:178 offset1:179
    v_mfma_f32_16x16x32_bf16 v[32:35], v[56:59], v[80:83], v[32:35]
    s_waitcnt lgkmcnt(15)
    v_mfma_f32_16x16x32_bf16 v[36:39], v[56:59], v[84:87], v[36:39]
    ds_read_b128 v[104:107], v140 offset:3776
    v_mfma_f32_16x16x32_bf16 v[20:23], v[52:55], v[72:75], v[20:23]
    ds_read2_b32 v[56:57], v138 offset0:48 offset1:49
    v_mfma_f32_16x16x32_bf16 v[24:27], v[52:55], v[76:79], v[24:27]
    ds_read2_b32 v[58:59], v138 offset0:50 offset1:51
    v_mfma_f32_16x16x32_bf16 v[28:31], v[52:55], v[80:83], v[28:31]
    v_mfma_f32_16x16x32_bf16 v[32:35], v[52:55], v[84:87], v[32:35]
    ds_read_b128 v[108:111], v140 offset:3264
    s_waitcnt lgkmcnt(15)
    v_mfma_f32_16x16x32_bf16 v[36:39], v[52:55], v[88:91], v[36:39]
    v_mfma_f32_16x16x32_bf16 v[16:19], v[48:51], v[72:75], v[16:19]
    ds_read2_b32 v[52:53], v137 offset0:176 offset1:177
    v_mfma_f32_16x16x32_bf16 v[20:23], v[48:51], v[76:79], v[20:23]
    ds_read2_b32 v[54:55], v137 offset0:178 offset1:179
    v_mfma_f32_16x16x32_bf16 v[24:27], v[48:51], v[80:83], v[24:27]
    v_mfma_f32_16x16x32_bf16 v[28:31], v[48:51], v[84:87], v[28:31]
    ds_read_b128 v[112:115], v140 offset:2752
    v_mfma_f32_16x16x32_bf16 v[32:35], v[48:51], v[88:91], v[32:35]
    v_mfma_f32_16x16x32_bf16 v[36:39], v[48:51], v[92:95], v[36:39]
    ds_read_b128 v[116:119], v140 offset:2240
    v_mfma_f32_16x16x32_bf16 v[12:15], v[44:47], v[72:75], v[12:15]
    ds_read2_b32 v[48:49], v137 offset0:48 offset1:49
    v_mfma_f32_16x16x32_bf16 v[16:19], v[44:47], v[76:79], v[16:19]
    ds_read2_b32 v[50:51], v137 offset0:50 offset1:51
    v_mfma_f32_16x16x32_bf16 v[20:23], v[44:47], v[80:83], v[20:23]
    v_mfma_f32_16x16x32_bf16 v[24:27], v[44:47], v[84:87], v[24:27]
    ds_read_b128 v[120:123], v140 offset:1728
    v_mfma_f32_16x16x32_bf16 v[28:31], v[44:47], v[88:91], v[28:31]
    v_mfma_f32_16x16x32_bf16 v[32:35], v[44:47], v[92:95], v[32:35]
    ds_read_b128 v[124:127], v140 offset:1216
    s_waitcnt lgkmcnt(15)
    v_mfma_f32_16x16x32_bf16 v[36:39], v[44:47], v[96:99], v[36:39]
    v_mfma_f32_16x16x32_bf16 v[8:11], v[40:43], v[72:75], v[8:11]
    ds_read2_b32 v[44:45], v136 offset0:176 offset1:177
    v_mfma_f32_16x16x32_bf16 v[12:15], v[40:43], v[76:79], v[12:15]
    ds_read2_b32 v[46:47], v136 offset0:178 offset1:179
    v_mfma_f32_16x16x32_bf16 v[16:19], v[40:43], v[80:83], v[16:19]
    v_mfma_f32_16x16x32_bf16 v[20:23], v[40:43], v[84:87], v[20:23]
    ds_read_b128 v[128:131], v140 offset:704
    v_mfma_f32_16x16x32_bf16 v[24:27], v[40:43], v[88:91], v[24:27]
    v_mfma_f32_16x16x32_bf16 v[28:31], v[40:43], v[92:95], v[28:31]
    ds_read_b128 v[132:135], v140 offset:192
    v_mfma_f32_16x16x32_bf16 v[32:35], v[40:43], v[96:99], v[32:35]
    v_mfma_f32_16x16x32_bf16 v[36:39], v[40:43], v[100:103], v[36:39]
    v_readfirstlane_b32 s41, v144
    s_cmp_eq_u32 s41, 3
    s_cselect_b32 s42, s42, 0x80000000
    s_mov_b64 exec, 1
    buffer_store_dword v145, v146, s[60:63], s42 offen sc1
    s_mov_b64 exec, -1
    s_waitcnt lgkmcnt(15)
    v_mfma_f32_16x16x32_bf16 v[36:39], v[68:71], v[104:107], v[36:39]
    ds_read2_b32 v[40:41], v136 offset0:48 offset1:49
    v_mfma_f32_16x16x32_bf16 v[32:35], v[64:67], v[104:107], v[32:35]
    ds_read2_b32 v[42:43], v136 offset0:50 offset1:51
    s_waitcnt lgkmcnt(14)
    v_mfma_f32_16x16x32_bf16 v[36:39], v[64:67], v[108:111], v[36:39]
    ds_read2_b32 v[68:69], v139 offset0:192 offset1:193
    v_mfma_f32_16x16x32_bf16 v[28:31], v[60:63], v[104:107], v[28:31]
    ds_read2_b32 v[70:71], v139 offset0:194 offset1:195
    v_mfma_f32_16x16x32_bf16 v[32:35], v[60:63], v[108:111], v[32:35]
    ds_read2_b32 v[64:65], v139 offset0:64 offset1:65
    s_waitcnt lgkmcnt(14)
    v_mfma_f32_16x16x32_bf16 v[36:39], v[60:63], v[112:115], v[36:39]
    ds_read2_b32 v[66:67], v139 offset0:66 offset1:67
    v_mfma_f32_16x16x32_bf16 v[24:27], v[56:59], v[104:107], v[24:27]
    ds_read2_b32 v[60:61], v138 offset0:192 offset1:193
    v_mfma_f32_16x16x32_bf16 v[28:31], v[56:59], v[108:111], v[28:31]
    ds_read2_b32 v[62:63], v138 offset0:194 offset1:195
    v_mfma_f32_16x16x32_bf16 v[32:35], v[56:59], v[112:115], v[32:35]
    s_waitcnt lgkmcnt(15)
    v_mfma_f32_16x16x32_bf16 v[36:39], v[56:59], v[116:119], v[36:39]
    ds_read_b128 v[72:75], v140 offset:3840
    v_mfma_f32_16x16x32_bf16 v[20:23], v[52:55], v[104:107], v[20:23]
    ds_read2_b32 v[56:57], v138 offset0:64 offset1:65
    v_mfma_f32_16x16x32_bf16 v[24:27], v[52:55], v[108:111], v[24:27]
    ds_read2_b32 v[58:59], v138 offset0:66 offset1:67
    v_mfma_f32_16x16x32_bf16 v[28:31], v[52:55], v[112:115], v[28:31]
    v_mfma_f32_16x16x32_bf16 v[32:35], v[52:55], v[116:119], v[32:35]
    ds_read_b128 v[76:79], v140 offset:3328
    s_waitcnt lgkmcnt(15)
    v_mfma_f32_16x16x32_bf16 v[36:39], v[52:55], v[120:123], v[36:39]
    v_mfma_f32_16x16x32_bf16 v[16:19], v[48:51], v[104:107], v[16:19]
    ds_read2_b32 v[52:53], v137 offset0:192 offset1:193
    v_mfma_f32_16x16x32_bf16 v[20:23], v[48:51], v[108:111], v[20:23]
    ds_read2_b32 v[54:55], v137 offset0:194 offset1:195
    v_mfma_f32_16x16x32_bf16 v[24:27], v[48:51], v[112:115], v[24:27]
    v_mfma_f32_16x16x32_bf16 v[28:31], v[48:51], v[116:119], v[28:31]
    ds_read_b128 v[80:83], v140 offset:2816
    v_mfma_f32_16x16x32_bf16 v[32:35], v[48:51], v[120:123], v[32:35]
    v_mfma_f32_16x16x32_bf16 v[36:39], v[48:51], v[124:127], v[36:39]
    ds_read_b128 v[84:87], v140 offset:2304
    s_waitcnt lgkmcnt(15)
    v_mfma_f32_16x16x32_bf16 v[12:15], v[44:47], v[104:107], v[12:15]
    ds_read2_b32 v[48:49], v137 offset0:64 offset1:65
    v_mfma_f32_16x16x32_bf16 v[16:19], v[44:47], v[108:111], v[16:19]
    ds_read2_b32 v[50:51], v137 offset0:66 offset1:67
    v_mfma_f32_16x16x32_bf16 v[20:23], v[44:47], v[112:115], v[20:23]
    v_mfma_f32_16x16x32_bf16 v[24:27], v[44:47], v[116:119], v[24:27]
    ds_read_b128 v[88:91], v140 offset:1792
    v_mfma_f32_16x16x32_bf16 v[28:31], v[44:47], v[120:123], v[28:31]
    v_mfma_f32_16x16x32_bf16 v[32:35], v[44:47], v[124:127], v[32:35]
    ds_read_b128 v[92:95], v140 offset:1280
    v_mfma_f32_16x16x32_bf16 v[36:39], v[44:47], v[128:131], v[36:39]
    s_waitcnt lgkmcnt(15)
    v_mfma_f32_16x16x32_bf16 v[8:11], v[40:43], v[104:107], v[8:11]
    ds_read2_b32 v[44:45], v136 offset0:192 offset1:193
    v_mfma_f32_16x16x32_bf16 v[12:15], v[40:43], v[108:111], v[12:15]
    ds_read2_b32 v[46:47], v136 offset0:194 offset1:195
    v_mfma_f32_16x16x32_bf16 v[16:19], v[40:43], v[112:115], v[16:19]
    v_mfma_f32_16x16x32_bf16 v[20:23], v[40:43], v[116:119], v[20:23]
    ds_read_b128 v[96:99], v140 offset:768
    v_mfma_f32_16x16x32_bf16 v[24:27], v[40:43], v[120:123], v[24:27]
    v_mfma_f32_16x16x32_bf16 v[28:31], v[40:43], v[124:127], v[28:31]
    ds_read_b128 v[100:103], v140 offset:256
    v_mfma_f32_16x16x32_bf16 v[32:35], v[40:43], v[128:131], v[32:35]
    v_mfma_f32_16x16x32_bf16 v[36:39], v[40:43], v[132:135], v[36:39]
    s_waitcnt lgkmcnt(15)
    v_mfma_f32_16x16x32_bf16 v[36:39], v[68:71], v[72:75], v[36:39]
    ds_read2_b32 v[40:41], v136 offset0:64 offset1:65
    v_mfma_f32_16x16x32_bf16 v[32:35], v[64:67], v[72:75], v[32:35]
    ds_read2_b32 v[42:43], v136 offset0:66 offset1:67
    s_waitcnt lgkmcnt(14)
    v_mfma_f32_16x16x32_bf16 v[36:39], v[64:67], v[76:79], v[36:39]
    ds_read2_b32 v[68:69], v139 offset0:208 offset1:209
    v_mfma_f32_16x16x32_bf16 v[28:31], v[60:63], v[72:75], v[28:31]
    ds_read2_b32 v[70:71], v139 offset0:210 offset1:211
    v_mfma_f32_16x16x32_bf16 v[32:35], v[60:63], v[76:79], v[32:35]
    ds_read2_b32 v[64:65], v139 offset0:80 offset1:81
    s_waitcnt lgkmcnt(14)
    v_mfma_f32_16x16x32_bf16 v[36:39], v[60:63], v[80:83], v[36:39]
    ds_read2_b32 v[66:67], v139 offset0:82 offset1:83
    v_mfma_f32_16x16x32_bf16 v[24:27], v[56:59], v[72:75], v[24:27]
    ds_read2_b32 v[60:61], v138 offset0:208 offset1:209
    v_mfma_f32_16x16x32_bf16 v[28:31], v[56:59], v[76:79], v[28:31]
    ds_read2_b32 v[62:63], v138 offset0:210 offset1:211
    v_mfma_f32_16x16x32_bf16 v[32:35], v[56:59], v[80:83], v[32:35]
    s_waitcnt lgkmcnt(15)
    v_mfma_f32_16x16x32_bf16 v[36:39], v[56:59], v[84:87], v[36:39]
    ds_read_b128 v[104:107], v140 offset:3904
    v_mfma_f32_16x16x32_bf16 v[20:23], v[52:55], v[72:75], v[20:23]
    ds_read2_b32 v[56:57], v138 offset0:80 offset1:81
    v_mfma_f32_16x16x32_bf16 v[24:27], v[52:55], v[76:79], v[24:27]
    ds_read2_b32 v[58:59], v138 offset0:82 offset1:83
    v_mfma_f32_16x16x32_bf16 v[28:31], v[52:55], v[80:83], v[28:31]
    v_mfma_f32_16x16x32_bf16 v[32:35], v[52:55], v[84:87], v[32:35]
    ds_read_b128 v[108:111], v140 offset:3392
    s_waitcnt lgkmcnt(15)
    v_mfma_f32_16x16x32_bf16 v[36:39], v[52:55], v[88:91], v[36:39]
    v_mfma_f32_16x16x32_bf16 v[16:19], v[48:51], v[72:75], v[16:19]
    ds_read2_b32 v[52:53], v137 offset0:208 offset1:209
    v_mfma_f32_16x16x32_bf16 v[20:23], v[48:51], v[76:79], v[20:23]
    ds_read2_b32 v[54:55], v137 offset0:210 offset1:211
    v_mfma_f32_16x16x32_bf16 v[24:27], v[48:51], v[80:83], v[24:27]
    v_mfma_f32_16x16x32_bf16 v[28:31], v[48:51], v[84:87], v[28:31]
    ds_read_b128 v[112:115], v140 offset:2880
    v_mfma_f32_16x16x32_bf16 v[32:35], v[48:51], v[88:91], v[32:35]
    v_mfma_f32_16x16x32_bf16 v[36:39], v[48:51], v[92:95], v[36:39]
    ds_read_b128 v[116:119], v140 offset:2368
    s_waitcnt lgkmcnt(15)
    v_mfma_f32_16x16x32_bf16 v[12:15], v[44:47], v[72:75], v[12:15]
    ds_read2_b32 v[48:49], v137 offset0:80 offset1:81
    v_mfma_f32_16x16x32_bf16 v[16:19], v[44:47], v[76:79], v[16:19]
    ds_read2_b32 v[50:51], v137 offset0:82 offset1:83
    v_mfma_f32_16x16x32_bf16 v[20:23], v[44:47], v[80:83], v[20:23]
    v_mfma_f32_16x16x32_bf16 v[24:27], v[44:47], v[84:87], v[24:27]
    ds_read_b128 v[120:123], v140 offset:1856
    v_mfma_f32_16x16x32_bf16 v[28:31], v[44:47], v[88:91], v[28:31]
    v_mfma_f32_16x16x32_bf16 v[32:35], v[44:47], v[92:95], v[32:35]
    ds_read_b128 v[124:127], v140 offset:1344
    v_mfma_f32_16x16x32_bf16 v[36:39], v[44:47], v[96:99], v[36:39]
    s_waitcnt lgkmcnt(15)
    v_mfma_f32_16x16x32_bf16 v[8:11], v[40:43], v[72:75], v[8:11]
    ds_read2_b32 v[44:45], v136 offset0:208 offset1:209
    v_mfma_f32_16x16x32_bf16 v[12:15], v[40:43], v[76:79], v[12:15]
    ds_read2_b32 v[46:47], v136 offset0:210 offset1:211
    v_mfma_f32_16x16x32_bf16 v[16:19], v[40:43], v[80:83], v[16:19]
    v_mfma_f32_16x16x32_bf16 v[20:23], v[40:43], v[84:87], v[20:23]
    ds_read_b128 v[128:131], v140 offset:832
    v_mfma_f32_16x16x32_bf16 v[24:27], v[40:43], v[88:91], v[24:27]
    v_mfma_f32_16x16x32_bf16 v[28:31], v[40:43], v[92:95], v[28:31]
    ds_read_b128 v[132:135], v140 offset:320
    v_mfma_f32_16x16x32_bf16 v[32:35], v[40:43], v[96:99], v[32:35]
    v_mfma_f32_16x16x32_bf16 v[36:39], v[40:43], v[100:103], v[36:39]
    s_waitcnt lgkmcnt(15)
    v_mfma_f32_16x16x32_bf16 v[36:39], v[68:71], v[104:107], v[36:39]
    ds_read2_b32 v[40:41], v136 offset0:80 offset1:81
    v_mfma_f32_16x16x32_bf16 v[32:35], v[64:67], v[104:107], v[32:35]
    ds_read2_b32 v[42:43], v136 offset0:82 offset1:83
    s_waitcnt lgkmcnt(14)
    v_mfma_f32_16x16x32_bf16 v[36:39], v[64:67], v[108:111], v[36:39]
    ds_read2_b32 v[68:69], v139 offset0:224 offset1:225
    v_mfma_f32_16x16x32_bf16 v[28:31], v[60:63], v[104:107], v[28:31]
    ds_read2_b32 v[70:71], v139 offset0:226 offset1:227
    v_mfma_f32_16x16x32_bf16 v[32:35], v[60:63], v[108:111], v[32:35]
    ds_read2_b32 v[64:65], v139 offset0:96 offset1:97
    s_waitcnt lgkmcnt(14)
    v_mfma_f32_16x16x32_bf16 v[36:39], v[60:63], v[112:115], v[36:39]
    ds_read2_b32 v[66:67], v139 offset0:98 offset1:99
    v_mfma_f32_16x16x32_bf16 v[24:27], v[56:59], v[104:107], v[24:27]
    ds_read2_b32 v[60:61], v138 offset0:224 offset1:225
    v_mfma_f32_16x16x32_bf16 v[28:31], v[56:59], v[108:111], v[28:31]
    ds_read2_b32 v[62:63], v138 offset0:226 offset1:227
    v_mfma_f32_16x16x32_bf16 v[32:35], v[56:59], v[112:115], v[32:35]
    s_waitcnt lgkmcnt(15)
    v_mfma_f32_16x16x32_bf16 v[36:39], v[56:59], v[116:119], v[36:39]
    ds_read_b128 v[72:75], v140 offset:3968
    v_mfma_f32_16x16x32_bf16 v[20:23], v[52:55], v[104:107], v[20:23]
    ds_read2_b32 v[56:57], v138 offset0:96 offset1:97
    v_mfma_f32_16x16x32_bf16 v[24:27], v[52:55], v[108:111], v[24:27]
    ds_read2_b32 v[58:59], v138 offset0:98 offset1:99
    v_mfma_f32_16x16x32_bf16 v[28:31], v[52:55], v[112:115], v[28:31]
    v_mfma_f32_16x16x32_bf16 v[32:35], v[52:55], v[116:119], v[32:35]
    ds_read_b128 v[76:79], v140 offset:3456
    s_waitcnt lgkmcnt(15)
    v_mfma_f32_16x16x32_bf16 v[36:39], v[52:55], v[120:123], v[36:39]
    v_mfma_f32_16x16x32_bf16 v[16:19], v[48:51], v[104:107], v[16:19]
    ds_read2_b32 v[52:53], v137 offset0:224 offset1:225
    v_mfma_f32_16x16x32_bf16 v[20:23], v[48:51], v[108:111], v[20:23]
    ds_read2_b32 v[54:55], v137 offset0:226 offset1:227
    v_mfma_f32_16x16x32_bf16 v[24:27], v[48:51], v[112:115], v[24:27]
    v_mfma_f32_16x16x32_bf16 v[28:31], v[48:51], v[116:119], v[28:31]
    ds_read_b128 v[80:83], v140 offset:2944
    v_mfma_f32_16x16x32_bf16 v[32:35], v[48:51], v[120:123], v[32:35]
    v_mfma_f32_16x16x32_bf16 v[36:39], v[48:51], v[124:127], v[36:39]
    ds_read_b128 v[84:87], v140 offset:2432
    s_waitcnt lgkmcnt(15)
    v_mfma_f32_16x16x32_bf16 v[12:15], v[44:47], v[104:107], v[12:15]
    ds_read2_b32 v[48:49], v137 offset0:96 offset1:97
    v_mfma_f32_16x16x32_bf16 v[16:19], v[44:47], v[108:111], v[16:19]
    ds_read2_b32 v[50:51], v137 offset0:98 offset1:99
    v_mfma_f32_16x16x32_bf16 v[20:23], v[44:47], v[112:115], v[20:23]
    v_mfma_f32_16x16x32_bf16 v[24:27], v[44:47], v[116:119], v[24:27]
    ds_read_b128 v[88:91], v140 offset:1920
    v_mfma_f32_16x16x32_bf16 v[28:31], v[44:47], v[120:123], v[28:31]
    v_mfma_f32_16x16x32_bf16 v[32:35], v[44:47], v[124:127], v[32:35]
    ds_read_b128 v[92:95], v140 offset:1408
    v_mfma_f32_16x16x32_bf16 v[36:39], v[44:47], v[128:131], v[36:39]
    s_waitcnt lgkmcnt(15)
    v_mfma_f32_16x16x32_bf16 v[8:11], v[40:43], v[104:107], v[8:11]
    ds_read2_b32 v[44:45], v136 offset0:224 offset1:225
    v_mfma_f32_16x16x32_bf16 v[12:15], v[40:43], v[108:111], v[12:15]
    ds_read2_b32 v[46:47], v136 offset0:226 offset1:227
    v_mfma_f32_16x16x32_bf16 v[16:19], v[40:43], v[112:115], v[16:19]
    v_mfma_f32_16x16x32_bf16 v[20:23], v[40:43], v[116:119], v[20:23]
    ds_read_b128 v[96:99], v140 offset:896
    v_mfma_f32_16x16x32_bf16 v[24:27], v[40:43], v[120:123], v[24:27]
    v_mfma_f32_16x16x32_bf16 v[28:31], v[40:43], v[124:127], v[28:31]
    ds_read_b128 v[100:103], v140 offset:384
    v_mfma_f32_16x16x32_bf16 v[32:35], v[40:43], v[128:131], v[32:35]
    v_mfma_f32_16x16x32_bf16 v[36:39], v[40:43], v[132:135], v[36:39]
    s_waitcnt lgkmcnt(15)
    v_mfma_f32_16x16x32_bf16 v[36:39], v[68:71], v[72:75], v[36:39]
    ds_read2_b32 v[40:41], v136 offset0:96 offset1:97
    v_mfma_f32_16x16x32_bf16 v[32:35], v[64:67], v[72:75], v[32:35]
    ds_read2_b32 v[42:43], v136 offset0:98 offset1:99
    s_waitcnt lgkmcnt(14)
    v_mfma_f32_16x16x32_bf16 v[36:39], v[64:67], v[76:79], v[36:39]
    ds_read2_b32 v[68:69], v139 offset0:240 offset1:241
    v_mfma_f32_16x16x32_bf16 v[28:31], v[60:63], v[72:75], v[28:31]
    ds_read2_b32 v[70:71], v139 offset0:242 offset1:243
    v_mfma_f32_16x16x32_bf16 v[32:35], v[60:63], v[76:79], v[32:35]
    ds_read2_b32 v[64:65], v139 offset0:112 offset1:113
    s_waitcnt lgkmcnt(14)
    v_mfma_f32_16x16x32_bf16 v[36:39], v[60:63], v[80:83], v[36:39]
    ds_read2_b32 v[66:67], v139 offset0:114 offset1:115
    v_mfma_f32_16x16x32_bf16 v[24:27], v[56:59], v[72:75], v[24:27]
    ds_read2_b32 v[60:61], v138 offset0:240 offset1:241
    v_mfma_f32_16x16x32_bf16 v[28:31], v[56:59], v[76:79], v[28:31]
    ds_read2_b32 v[62:63], v138 offset0:242 offset1:243
    v_mfma_f32_16x16x32_bf16 v[32:35], v[56:59], v[80:83], v[32:35]
    s_waitcnt lgkmcnt(15)
    v_mfma_f32_16x16x32_bf16 v[36:39], v[56:59], v[84:87], v[36:39]
    ds_read_b128 v[104:107], v140 offset:4032
    v_mfma_f32_16x16x32_bf16 v[20:23], v[52:55], v[72:75], v[20:23]
    ds_read2_b32 v[56:57], v138 offset0:112 offset1:113
    v_mfma_f32_16x16x32_bf16 v[24:27], v[52:55], v[76:79], v[24:27]
    ds_read2_b32 v[58:59], v138 offset0:114 offset1:115
    v_mfma_f32_16x16x32_bf16 v[28:31], v[52:55], v[80:83], v[28:31]
    v_mfma_f32_16x16x32_bf16 v[32:35], v[52:55], v[84:87], v[32:35]
    ds_read_b128 v[108:111], v140 offset:3520
    s_waitcnt lgkmcnt(15)
    v_mfma_f32_16x16x32_bf16 v[36:39], v[52:55], v[88:91], v[36:39]
    v_mfma_f32_16x16x32_bf16 v[16:19], v[48:51], v[72:75], v[16:19]
    ds_read2_b32 v[52:53], v137 offset0:240 offset1:241
    v_mfma_f32_16x16x32_bf16 v[20:23], v[48:51], v[76:79], v[20:23]
    ds_read2_b32 v[54:55], v137 offset0:242 offset1:243
    v_mfma_f32_16x16x32_bf16 v[24:27], v[48:51], v[80:83], v[24:27]
    v_mfma_f32_16x16x32_bf16 v[28:31], v[48:51], v[84:87], v[28:31]
    ds_read_b128 v[112:115], v140 offset:3008
    v_mfma_f32_16x16x32_bf16 v[32:35], v[48:51], v[88:91], v[32:35]
    v_mfma_f32_16x16x32_bf16 v[36:39], v[48:51], v[92:95], v[36:39]
    ds_read_b128 v[116:119], v140 offset:2496
    s_waitcnt lgkmcnt(15)
    v_mfma_f32_16x16x32_bf16 v[12:15], v[44:47], v[72:75], v[12:15]
    ds_read2_b32 v[48:49], v137 offset0:112 offset1:113
    v_mfma_f32_16x16x32_bf16 v[16:19], v[44:47], v[76:79], v[16:19]
    ds_read2_b32 v[50:51], v137 offset0:114 offset1:115
    v_mfma_f32_16x16x32_bf16 v[20:23], v[44:47], v[80:83], v[20:23]
    v_mfma_f32_16x16x32_bf16 v[24:27], v[44:47], v[84:87], v[24:27]
    ds_read_b128 v[120:123], v140 offset:1984
    v_mfma_f32_16x16x32_bf16 v[28:31], v[44:47], v[88:91], v[28:31]
    v_mfma_f32_16x16x32_bf16 v[32:35], v[44:47], v[92:95], v[32:35]
    ds_read_b128 v[124:127], v140 offset:1472
    v_mfma_f32_16x16x32_bf16 v[36:39], v[44:47], v[96:99], v[36:39]
    s_waitcnt lgkmcnt(15)
    v_mfma_f32_16x16x32_bf16 v[8:11], v[40:43], v[72:75], v[8:11]
    ds_read2_b32 v[44:45], v136 offset0:240 offset1:241
    v_mfma_f32_16x16x32_bf16 v[12:15], v[40:43], v[76:79], v[12:15]
    ds_read2_b32 v[46:47], v136 offset0:242 offset1:243
    v_mfma_f32_16x16x32_bf16 v[16:19], v[40:43], v[80:83], v[16:19]
    v_mfma_f32_16x16x32_bf16 v[20:23], v[40:43], v[84:87], v[20:23]
    ds_read_b128 v[128:131], v140 offset:960
    v_mfma_f32_16x16x32_bf16 v[24:27], v[40:43], v[88:91], v[24:27]
    v_mfma_f32_16x16x32_bf16 v[28:31], v[40:43], v[92:95], v[28:31]
    ds_read_b128 v[132:135], v140 offset:448
    v_mfma_f32_16x16x32_bf16 v[32:35], v[40:43], v[96:99], v[32:35]
    v_mfma_f32_16x16x32_bf16 v[36:39], v[40:43], v[100:103], v[36:39]
    s_waitcnt lgkmcnt(15)
    v_mfma_f32_16x16x32_bf16 v[36:39], v[68:71], v[104:107], v[36:39]
    ds_read2_b32 v[40:41], v136 offset0:112 offset1:113
    v_mfma_f32_16x16x32_bf16 v[32:35], v[64:67], v[104:107], v[32:35]
    ds_read2_b32 v[42:43], v136 offset0:114 offset1:115
    s_waitcnt lgkmcnt(14)
    v_mfma_f32_16x16x32_bf16 v[36:39], v[64:67], v[108:111], v[36:39]
    v_mfma_f32_16x16x32_bf16 v[28:31], v[60:63], v[104:107], v[28:31]
    v_mfma_f32_16x16x32_bf16 v[32:35], v[60:63], v[108:111], v[32:35]
    s_waitcnt lgkmcnt(11)
    v_mfma_f32_16x16x32_bf16 v[36:39], v[60:63], v[112:115], v[36:39]
    v_mfma_f32_16x16x32_bf16 v[24:27], v[56:59], v[104:107], v[24:27]
    v_mfma_f32_16x16x32_bf16 v[28:31], v[56:59], v[108:111], v[28:31]
    v_mfma_f32_16x16x32_bf16 v[32:35], v[56:59], v[112:115], v[32:35]
    s_waitcnt lgkmcnt(10)
    v_mfma_f32_16x16x32_bf16 v[36:39], v[56:59], v[116:119], v[36:39]
    v_mfma_f32_16x16x32_bf16 v[20:23], v[52:55], v[104:107], v[20:23]
    v_mfma_f32_16x16x32_bf16 v[24:27], v[52:55], v[108:111], v[24:27]
    v_mfma_f32_16x16x32_bf16 v[28:31], v[52:55], v[112:115], v[28:31]
    v_mfma_f32_16x16x32_bf16 v[32:35], v[52:55], v[116:119], v[32:35]
    s_waitcnt lgkmcnt(7)
    v_mfma_f32_16x16x32_bf16 v[36:39], v[52:55], v[120:123], v[36:39]
    v_mfma_f32_16x16x32_bf16 v[16:19], v[48:51], v[104:107], v[16:19]
    v_mfma_f32_16x16x32_bf16 v[20:23], v[48:51], v[108:111], v[20:23]
    v_mfma_f32_16x16x32_bf16 v[24:27], v[48:51], v[112:115], v[24:27]
    v_mfma_f32_16x16x32_bf16 v[28:31], v[48:51], v[116:119], v[28:31]
    v_mfma_f32_16x16x32_bf16 v[32:35], v[48:51], v[120:123], v[32:35]
    s_waitcnt lgkmcnt(6)
    v_mfma_f32_16x16x32_bf16 v[36:39], v[48:51], v[124:127], v[36:39]
    s_waitcnt lgkmcnt(4)
    v_mfma_f32_16x16x32_bf16 v[12:15], v[44:47], v[104:107], v[12:15]
    ds_read_b64 v[72:73], v142 offset:3584
    v_mfma_f32_16x16x32_bf16 v[16:19], v[44:47], v[108:111], v[16:19]
    ds_read_b64 v[74:75], v142 offset:3072
    v_mfma_f32_16x16x32_bf16 v[20:23], v[44:47], v[112:115], v[20:23]
    ds_read_b64 v[76:77], v142 offset:2560
    v_mfma_f32_16x16x32_bf16 v[24:27], v[44:47], v[116:119], v[24:27]
    ds_read_b64 v[78:79], v142 offset:2048
    v_mfma_f32_16x16x32_bf16 v[28:31], v[44:47], v[120:123], v[28:31]
    v_mfma_f32_16x16x32_bf16 v[32:35], v[44:47], v[124:127], v[32:35]
    s_waitcnt lgkmcnt(7)
    v_mfma_f32_16x16x32_bf16 v[36:39], v[44:47], v[128:131], v[36:39]
    s_waitcnt lgkmcnt(4)
    v_mfma_f32_16x16x32_bf16 v[8:11], v[40:43], v[104:107], v[8:11]
    ds_read_b64 v[80:81], v142 offset:1536
    v_mfma_f32_16x16x32_bf16 v[12:15], v[40:43], v[108:111], v[12:15]
    ds_read_b64 v[82:83], v142 offset:1024
    v_mfma_f32_16x16x32_bf16 v[16:19], v[40:43], v[112:115], v[16:19]
    ds_read_b64 v[84:85], v142 offset:512
    v_mfma_f32_16x16x32_bf16 v[20:23], v[40:43], v[116:119], v[20:23]
    ds_read_b64 v[86:87], v142 offset:0
    v_mfma_f32_16x16x32_bf16 v[24:27], v[40:43], v[120:123], v[24:27]
    v_mfma_f32_16x16x32_bf16 v[28:31], v[40:43], v[124:127], v[28:31]
    v_mfma_f32_16x16x32_bf16 v[32:35], v[40:43], v[128:131], v[32:35]
    v_mfma_f32_16x16x32_bf16 v[36:39], v[40:43], v[132:135], v[36:39]
    s_waitcnt lgkmcnt(0)
    v_dot2_f32_bf16 v40, v73, s69, v8
    v_dot2_f32_bf16 v41, v73, s68, v9
    v_dot2_f32_bf16 v42, v72, s69, v10
    v_dot2_f32_bf16 v43, v72, s68, v11
    v_dot2_f32_bf16 v44, v75, s69, v12
    v_dot2_f32_bf16 v45, v75, s68, v13
    v_dot2_f32_bf16 v46, v74, s69, v14
    v_dot2_f32_bf16 v47, v74, s68, v15
    v_dot2_f32_bf16 v48, v77, s69, v16
    v_dot2_f32_bf16 v49, v77, s68, v17
    v_dot2_f32_bf16 v50, v76, s69, v18
    v_dot2_f32_bf16 v51, v76, s68, v19
    v_cvt_pk_bf16_f32 v88, v40, v41
    v_cvt_pk_bf16_f32 v89, v42, v43
    v_cvt_pk_bf16_f32 v90, v44, v45
    v_cvt_pk_bf16_f32 v91, v46, v47
    v_dot2_f32_bf16 v52, v79, s69, v20
    v_dot2_f32_bf16 v53, v79, s68, v21
    v_dot2_f32_bf16 v54, v78, s69, v22
    v_dot2_f32_bf16 v55, v78, s68, v23
    v_permlane16_swap_b32 v88, v90
    v_permlane16_swap_b32 v89, v91
    buffer_store_dwordx4 v[88:91], v141, s[60:63], s40 offen offset:0 sc1
    v_dot2_f32_bf16 v56, v81, s69, v24
    v_dot2_f32_bf16 v57, v81, s68, v25
    v_dot2_f32_bf16 v58, v80, s69, v26
    v_dot2_f32_bf16 v59, v80, s68, v27
    v_cvt_pk_bf16_f32 v92, v48, v49
    v_cvt_pk_bf16_f32 v93, v50, v51
    v_cvt_pk_bf16_f32 v94, v52, v53
    v_cvt_pk_bf16_f32 v95, v54, v55
    v_dot2_f32_bf16 v60, v83, s69, v28
    v_dot2_f32_bf16 v61, v83, s68, v29
    v_dot2_f32_bf16 v62, v82, s69, v30
    v_dot2_f32_bf16 v63, v82, s68, v31
    v_permlane16_swap_b32 v92, v94
    v_permlane16_swap_b32 v93, v95
    buffer_store_dwordx4 v[92:95], v141, s[60:63], s40 offen offset:1024 sc1
    v_dot2_f32_bf16 v64, v85, s69, v32
    v_dot2_f32_bf16 v65, v85, s68, v33
    v_dot2_f32_bf16 v66, v84, s69, v34
    v_dot2_f32_bf16 v67, v84, s68, v35
    v_cvt_pk_bf16_f32 v96, v56, v57
    v_cvt_pk_bf16_f32 v97, v58, v59
    v_cvt_pk_bf16_f32 v98, v60, v61
    v_cvt_pk_bf16_f32 v99, v62, v63
    v_dot2_f32_bf16 v68, v87, s69, v36
    v_dot2_f32_bf16 v69, v87, s68, v37
    v_dot2_f32_bf16 v70, v86, s69, v38
    v_dot2_f32_bf16 v71, v86, s68, v39
    v_permlane16_swap_b32 v96, v98
    v_permlane16_swap_b32 v97, v99
    buffer_store_dwordx4 v[96:99], v141, s[60:63], s40 offen offset:2048 sc1
    v_cvt_pk_bf16_f32 v100, v64, v65
    v_cvt_pk_bf16_f32 v101, v66, v67
    v_cvt_pk_bf16_f32 v102, v68, v69
    v_cvt_pk_bf16_f32 v103, v70, v71
    s_nop 0
    v_permlane16_swap_b32 v100, v102
    v_permlane16_swap_b32 v101, v103
    buffer_store_dwordx4 v[100:103], v141, s[60:63], s40 offen offset:3072 sc1
    s_endpgm
K_FFN:
    s_sub_u32 s65, s17, 20
    s_mul_i32 s64, s16, 12
    s_add_u32 s64, s64, s65
    v_lshrrev_b32 v8, 1, v1
    v_mul_u32_u24 v8, 3072, v8
    v_and_b32 v9, 1, v1
    v_lshl_add_u32 v8, v9, 4, v8
    s_mul_i32 s40, s3, 491520
    s_lshl_b32 s41, s64, 5
    s_add_u32 s67, s40, s41
    s_mul_i32 s68, s3, 5120
    s_mul_i32 s59, s64, 20480
    s_mul_i32 s41, s3, 320
    s_add_u32 s59, s59, s41
    v_and_b32 v2, 15, v1
    v_lshrrev_b32 v3, 4, v1
    v_lshlrev_b32 v10, 4, v2
    v_lshl_add_u32 v10, v3, 7, v10
    s_mul_i32 s66, s64, 20480
    s_mul_i32 s41, s3, 5120
    s_add_u32 s66, s66, s41
    s_add_u32 s66, s66, 8388608
    s_lshl_b32 s18, s3, 13
    s_add_u32 s18, s18, 65536
    s_add_u32 s19, s18, 4096
    v_lshrrev_b32 v4, 2, v1
    v_and_b32 v5, 3, v1
    v_lshlrev_b32 v5, 4, v5
    v_lshl_add_u32 v4, v4, 7, v5
    s_mov_b32 s41, 0xcccd
    s_mov_b32 s28, s46
    s_mov_b32 s29, s47
    s_mov_b32 s30, 1966080
    s_mov_b32 s31, 0x20000
    s_mov_b32 s32, s48
    s_mov_b32 s33, s49
    s_mov_b32 s34, 1966080
    s_mov_b32 s35, 0x20000
    s_mov_b32 s36, s50
    s_mov_b32 s37, s51
    s_mov_b32 s38, 1966080
    s_mov_b32 s39, 0x20000
    v_add_u32 v104, 0, v1
    v_mul_u32_u24 v9, s41, v104
    v_lshrrev_b32 v9, 20, v9
    v_mul_u32_u24 v9, 960, v9
    v_lshl_add_u32 v104, v104, 4, v9
    v_add_u32 v105, 64, v1
    v_mul_u32_u24 v9, s41, v105
    v_lshrrev_b32 v9, 20, v9
    v_mul_u32_u24 v9, 960, v9
    v_lshl_add_u32 v105, v105, 4, v9
    v_add_u32 v106, 128, v1
    v_mul_u32_u24 v9, s41, v106
    v_lshrrev_b32 v9, 20, v9
    v_mul_u32_u24 v9, 960, v9
    v_lshl_add_u32 v106, v106, 4, v9
    v_add_u32 v107, 192, v1
    v_mul_u32_u24 v9, s41, v107
    v_lshrrev_b32 v9, 20, v9
    v_mul_u32_u24 v9, 960, v9
    v_lshl_add_u32 v107, v107, 4, v9
    v_add_u32 v108, 256, v1
    v_mul_u32_u24 v9, s41, v108
    v_lshrrev_b32 v9, 20, v9
    v_mul_u32_u24 v9, 960, v9
    v_lshl_add_u32 v108, v108, 4, v9
    s_mov_b32 s40, 0xffff0000
    s_mov_b32 s41, 0xffff0000
    s_mov_b32 s42, 0
    s_mov_b32 s43, -1
    s_mov_b32 s72, 0xcccccccc
    s_mov_b32 s73, 0xcccccccc
    s_mov_b32 s74, 0xaaaaaaaa
    s_mov_b32 s75, 0xaaaaaaaa
    s_mov_b32 s76, 0x00010001
    s_mov_b32 s77, 0x00010001
    v_mov_b32 v34, 0
    v_mov_b32 v12, 1
    s_mov_b32 s57, 0
LW_26:
    ds_read_b32 v9, v11 offset:32
    s_waitcnt lgkmcnt(0)
    v_cmp_gt_u32 vcc, 5, v9
    s_cbranch_vccz LW_26_x
    s_add_u32 s57, s57, 1
    s_cmp_lt_u32 s57, 100000
    s_cbranch_scc1 LW_26
LW_26_x:
    buffer_load_dwordx4 v[16:19], v4, s[60:63], s18 offen offset:0 sc1
    buffer_load_dwordx4 v[20:23], v4, s[60:63], s18 offen offset:2048 sc1
    buffer_load_dwordx4 v[24:27], v4, s[60:63], s19 offen offset:0 sc1
    buffer_load_dwordx4 v[28:31], v4, s[60:63], s19 offen offset:2048 sc1
    s_mov_b64 exec, 1
    ds_add_u32 v11, v12 offset:40
    s_mov_b64 exec, -1
    s_waitcnt vmcnt(0)
    v_max3_u32 v32, v17, v19, v21
    v_max3_u32 v32, v32, v23, v25
    v_max3_u32 v32, v32, v27, v29
    v_max_u32 v32, v32, v31
    v_min3_u32 v33, v17, v19, v21
    v_min3_u32 v33, v33, v23, v25
    v_min3_u32 v33, v33, v27, v29
    v_min_u32 v33, v33, v31
    v_xor_b32 v32, s56, v32
    v_xor_b32 v33, s56, v33
    v_or_b32 v32, v32, v33
    v_cmp_ne_u32 vcc, 0, v32
    s_cbranch_vccz FK0_27
    s_mov_b64 exec, vcc
    s_mov_b32 s57, 0
FK_28:
    buffer_load_dwordx4 v[16:19], v4, s[60:63], s18 offen offset:0 sc1
    buffer_load_dwordx4 v[20:23], v4, s[60:63], s18 offen offset:2048 sc1
    buffer_load_dwordx4 v[24:27], v4, s[60:63], s19 offen offset:0 sc1
    buffer_load_dwordx4 v[28:31], v4, s[60:63], s19 offen offset:2048 sc1
    s_waitcnt vmcnt(0)
    v_max3_u32 v32, v17, v19, v21
    v_max3_u32 v32, v32, v23, v25
    v_max3_u32 v32, v32, v27, v29
    v_max_u32 v32, v32, v31
    v_min3_u32 v33, v17, v19, v21
    v_min3_u32 v33, v33, v23, v25
    v_min3_u32 v33, v33, v27, v29
    v_min_u32 v33, v33, v31
    v_xor_b32 v32, s56, v32
    v_xor_b32 v33, s56, v33
    v_or_b32 v32, v32, v33
    v_cmp_ne_u32 vcc, 0, v32
    s_and_b64 exec, exec, vcc
    s_cbranch_execz FK_28_x
    s_sleep 1
    s_add_u32 s57, s57, 1
    s_cmp_lt_u32 s57, 100000
    s_cbranch_scc1 FK_28
FK_28_x:
    s_mov_b64 exec, -1
FK0_27:
    v_max_u32 v17, v16, v18
    v_min_u32 v18, v16, v18
    v_max_u32 v16, v20, v22
    v_min_u32 v22, v20, v22
    v_max_u32 v20, v24, v26
    v_min_u32 v26, v24, v26
    v_max_u32 v24, v28, v30
    v_min_u32 v30, v28, v30
    v_max_u32 v28, v17, v16
    v_min_u32 v16, v17, v16
    v_max_u32 v17, v18, v22
    v_min_u32 v22, v18, v22
    v_max_u32 v18, v20, v24
    v_min_u32 v24, v20, v24
    v_max_u32 v20, v26, v30
    v_min_u32 v30, v26, v30
    v_max_u32 v26, v17, v16
    v_min_u32 v16, v17, v16
    v_max_u32 v17, v20, v24
    v_min_u32 v24, v20, v24
    v_max_u32 v20, v28, v18
    v_min_u32 v18, v28, v18
    v_max_u32 v28, v22, v30
    v_min_u32 v30, v22, v30
    v_max_u32 v22, v26, v17
    v_min_u32 v17, v26, v17
    v_max_u32 v26, v16, v24
    v_min_u32 v24, v16, v24
    v_max_u32 v16, v22, v18
    v_min_u32 v18, v22, v18
    v_max_u32 v22, v28, v24
    v_min_u32 v24, v28, v24
    v_max_u32 v28, v26, v18
    v_min_u32 v18, v26, v18
    v_max_u32 v26, v22, v17
    v_min_u32 v17, v22, v17
    v_max_u32 v22, v26, v18
    v_min_u32 v18, v26, v18
    v_max_u32_dpp v33, v20, v20 row_ror:8 row_mask:0xf bank_mask:0xf
    s_nop 1
    v_max_u32_dpp v33, v33, v33 row_ror:4 row_mask:0xf bank_mask:0xf
    s_nop 1
    v_max_u32_dpp v33, v33, v33 row_ror:2 row_mask:0xf bank_mask:0xf
    s_nop 1
    v_max_u32_dpp v33, v33, v33 row_ror:1 row_mask:0xf bank_mask:0xf
    v_cmp_eq_u32 vcc, v33, v20
    v_cndmask_b32 v34, v34, v33, s[76:77]
    s_lshl_b64 s[76:77], s[76:77], 1
    v_cndmask_b32 v20, v20, v16, vcc
    v_cndmask_b32 v16, v16, v28, vcc
    v_cndmask_b32 v28, v28, v22, vcc
    v_cndmask_b32 v22, v22, v18, vcc
    v_cndmask_b32 v18, v18, v17, vcc
    v_cndmask_b32 v17, v17, v24, vcc
    v_cndmask_b32 v24, v24, v30, vcc
    v_max_u32_dpp v33, v20, v20 row_ror:8 row_mask:0xf bank_mask:0xf
    s_nop 1
    v_max_u32_dpp v33, v33, v33 row_ror:4 row_mask:0xf bank_mask:0xf
    s_nop 1
    v_max_u32_dpp v33, v33, v33 row_ror:2 row_mask:0xf bank_mask:0xf
    s_nop 1
    v_max_u32_dpp v33, v33, v33 row_ror:1 row_mask:0xf bank_mask:0xf
    v_cmp_eq_u32 vcc, v33, v20
    v_cndmask_b32 v34, v34, v33, s[76:77]
    s_lshl_b64 s[76:77], s[76:77], 1
    v_cndmask_b32 v20, v20, v16, vcc
    v_cndmask_b32 v16, v16, v28, vcc
    v_cndmask_b32 v28, v28, v22, vcc
    v_cndmask_b32 v22, v22, v18, vcc
    v_cndmask_b32 v18, v18, v17, vcc
    v_cndmask_b32 v17, v17, v24, vcc
    v_max_u32_dpp v33, v20, v20 row_ror:8 row_mask:0xf bank_mask:0xf
    s_nop 1
    v_max_u32_dpp v33, v33, v33 row_ror:4 row_mask:0xf bank_mask:0xf
    s_nop 1
    v_max_u32_dpp v33, v33, v33 row_ror:2 row_mask:0xf bank_mask:0xf
    s_nop 1
    v_max_u32_dpp v33, v33, v33 row_ror:1 row_mask:0xf bank_mask:0xf
    v_cmp_eq_u32 vcc, v33, v20
    v_cndmask_b32 v34, v34, v33, s[76:77]
    s_lshl_b64 s[76:77], s[76:77], 1
    v_cndmask_b32 v20, v20, v16, vcc
    v_cndmask_b32 v16, v16, v28, vcc
    v_cndmask_b32 v28, v28, v22, vcc
    v_cndmask_b32 v22, v22, v18, vcc
    v_cndmask_b32 v18, v18, v17, vcc
    v_max_u32_dpp v33, v20, v20 row_ror:8 row_mask:0xf bank_mask:0xf
    s_nop 1
    v_max_u32_dpp v33, v33, v33 row_ror:4 row_mask:0xf bank_mask:0xf
    s_nop 1
    v_max_u32_dpp v33, v33, v33 row_ror:2 row_mask:0xf bank_mask:0xf
    s_nop 1
    v_max_u32_dpp v33, v33, v33 row_ror:1 row_mask:0xf bank_mask:0xf
    v_cmp_eq_u32 vcc, v33, v20
    v_cndmask_b32 v34, v34, v33, s[76:77]
    s_lshl_b64 s[76:77], s[76:77], 1
    v_cndmask_b32 v20, v20, v16, vcc
    v_cndmask_b32 v16, v16, v28, vcc
    v_cndmask_b32 v28, v28, v22, vcc
    v_cndmask_b32 v22, v22, v18, vcc
    v_max_u32_dpp v33, v20, v20 row_ror:8 row_mask:0xf bank_mask:0xf
    s_nop 1
    v_max_u32_dpp v33, v33, v33 row_ror:4 row_mask:0xf bank_mask:0xf
    s_nop 1
    v_max_u32_dpp v33, v33, v33 row_ror:2 row_mask:0xf bank_mask:0xf
    s_nop 1
    v_max_u32_dpp v33, v33, v33 row_ror:1 row_mask:0xf bank_mask:0xf
    v_cmp_eq_u32 vcc, v33, v20
    v_cndmask_b32 v34, v34, v33, s[76:77]
    s_lshl_b64 s[76:77], s[76:77], 1
    v_cndmask_b32 v20, v20, v16, vcc
    v_cndmask_b32 v16, v16, v28, vcc
    v_cndmask_b32 v28, v28, v22, vcc
    v_max_u32_dpp v33, v20, v20 row_ror:8 row_mask:0xf bank_mask:0xf
    s_nop 1
    v_max_u32_dpp v33, v33, v33 row_ror:4 row_mask:0xf bank_mask:0xf
    s_nop 1
    v_max_u32_dpp v33, v33, v33 row_ror:2 row_mask:0xf bank_mask:0xf
    s_nop 1
    v_max_u32_dpp v33, v33, v33 row_ror:1 row_mask:0xf bank_mask:0xf
    v_cmp_eq_u32 vcc, v33, v20
    v_cndmask_b32 v34, v34, v33, s[76:77]
    s_lshl_b64 s[76:77], s[76:77], 1
    v_cndmask_b32 v20, v20, v16, vcc
    v_cndmask_b32 v16, v16, v28, vcc
    s_nop 0
    v_max_u32_dpp v33, v20, v20 row_ror:8 row_mask:0xf bank_mask:0xf
    s_nop 1
    v_max_u32_dpp v33, v33, v33 row_ror:4 row_mask:0xf bank_mask:0xf
    s_nop 1
    v_max_u32_dpp v33, v33, v33 row_ror:2 row_mask:0xf bank_mask:0xf
    s_nop 1
    v_max_u32_dpp v33, v33, v33 row_ror:1 row_mask:0xf bank_mask:0xf
    v_cmp_eq_u32 vcc, v33, v20
    v_cndmask_b32 v34, v34, v33, s[76:77]
    s_lshl_b64 s[76:77], s[76:77], 1
    v_cndmask_b32 v20, v20, v16, vcc
    s_nop 1
    v_max_u32_dpp v33, v20, v20 row_ror:8 row_mask:0xf bank_mask:0xf
    s_nop 1
    v_max_u32_dpp v33, v33, v33 row_ror:4 row_mask:0xf bank_mask:0xf
    s_nop 1
    v_max_u32_dpp v33, v33, v33 row_ror:2 row_mask:0xf bank_mask:0xf
    s_nop 1
    v_max_u32_dpp v33, v33, v33 row_ror:1 row_mask:0xf bank_mask:0xf
    v_cndmask_b32 v34, v34, v33, s[76:77]
    s_lshl_b64 s[76:77], s[76:77], 1
    s_nop 0
    v_mov_b32_dpp v32, v34 row_half_mirror row_mask:0xf bank_mask:0xf
    v_mov_b32_dpp v33, v34 row_half_mirror row_mask:0xf bank_mask:0xf
    s_nop 1
    v_permlane16_swap_b32 v32, v33
    v_cndmask_b32 v32, v33, v32, s[40:41]
    v_max_u32 v34, v34, v32
    s_nop 1
    v_max_u32_dpp v32, v34, v34 row_shl:4 row_mask:0xf bank_mask:0x5
    s_nop 1
    v_min_u32_dpp v32, v34, v34 row_shr:4 row_mask:0xf bank_mask:0xa
    s_nop 1
    v_max_u32_dpp v34, v32, v32 quad_perm:[2,3,0,1] row_mask:0xf bank_mask:0xf
    v_min_u32_dpp v32, v32, v32 quad_perm:[2,3,0,1] row_mask:0xf bank_mask:0xf
    v_cndmask_b32 v34, v34, v32, s[72:73]
    s_nop 1
    v_max_u32_dpp v32, v34, v34 quad_perm:[1,0,3,2] row_mask:0xf bank_mask:0xf
    v_min_u32_dpp v34, v34, v34 quad_perm:[1,0,3,2] row_mask:0xf bank_mask:0xf
    v_cndmask_b32 v34, v32, v34, s[74:75]
    s_nop 1
    v_mov_b32_dpp v32, v34 row_half_mirror row_mask:0xf bank_mask:0xf
    v_mov_b32_dpp v33, v34 row_half_mirror row_mask:0xf bank_mask:0xf
    s_nop 1
    v_permlane32_swap_b32 v32, v33
    v_cndmask_b32 v32, v33, v32, s[42:43]
    v_max_u32 v34, v34, v32
    s_nop 1
    v_max_u32_dpp v32, v34, v34 row_shl:4 row_mask:0xf bank_mask:0x5
    s_nop 1
    v_min_u32_dpp v32, v34, v34 row_shr:4 row_mask:0xf bank_mask:0xa
    s_nop 1
    v_max_u32_dpp v34, v32, v32 quad_perm:[2,3,0,1] row_mask:0xf bank_mask:0xf
    v_min_u32_dpp v32, v32, v32 quad_perm:[2,3,0,1] row_mask:0xf bank_mask:0xf
    v_cndmask_b32 v34, v34, v32, s[72:73]
    s_nop 1
    v_max_u32_dpp v32, v34, v34 quad_perm:[1,0,3,2] row_mask:0xf bank_mask:0xf
    v_min_u32_dpp v34, v34, v34 quad_perm:[1,0,3,2] row_mask:0xf bank_mask:0xf
    v_cndmask_b32 v34, v32, v34, s[74:75]
    s_lshl_b32 s76, s3, 5
    s_add_u32 s76, s76, 61504
    v_lshl_add_u32 v35, v1, 2, s76
    v_and_b32 v36, 7, v1
    v_lshlrev_b32 v36, 2, v36
    v_lshl_add_u32 v36, v3, 5, v36
    s_mov_b64 exec, 0xff
    ds_write_b32 v35, v34
    s_mov_b64 exec, 1
    ds_add_u32 v11, v12 offset:0
    s_mov_b64 exec, -1
    s_mov_b32 s57, 0
LW_29:
    ds_read_b32 v35, v11 offset:0
    s_waitcnt lgkmcnt(0)
    v_cmp_gt_u32 vcc, 4, v35
    s_cbranch_vccz LW_29_x
    s_add_u32 s57, s57, 1
    s_cmp_lt_u32 s57, 100000
    s_cbranch_scc1 LW_29
LW_29_x:
    ds_read_b32 v34, v36 offset:61504
    s_mul_i32 s76, s3, 320
    v_lshl_add_u32 v36, v3, 4, s76
    v_bfe_u32 v37, v1, 3, 1
    v_lshl_add_u32 v36, v37, 6, v36
    s_mov_b32 s77, 65600
    s_waitcnt lgkmcnt(0)
    v_mov_b32_dpp v32, v34 row_half_mirror row_mask:0xf bank_mask:0xf
    v_mov_b32_dpp v33, v34 row_half_mirror row_mask:0xf bank_mask:0xf
    s_nop 1
    v_permlane16_swap_b32 v32, v33
    v_cndmask_b32 v32, v33, v32, s[40:41]
    v_max_u32 v34, v34, v32
    s_nop 1
    v_max_u32_dpp v32, v34, v34 row_shl:4 row_mask:0xf bank_mask:0x5
    s_nop 1
    v_min_u32_dpp v32, v34, v34 row_shr:4 row_mask:0xf bank_mask:0xa
    s_nop 1
    v_max_u32_dpp v34, v32, v32 quad_perm:[2,3,0,1] row_mask:0xf bank_mask:0xf
    v_min_u32_dpp v32, v32, v32 quad_perm:[2,3,0,1] row_mask:0xf bank_mask:0xf
    v_cndmask_b32 v34, v34, v32, s[72:73]
    s_nop 1
    v_max_u32_dpp v32, v34, v34 quad_perm:[1,0,3,2] row_mask:0xf bank_mask:0xf
    v_min_u32_dpp v34, v34, v34 quad_perm:[1,0,3,2] row_mask:0xf bank_mask:0xf
    v_cndmask_b32 v34, v32, v34, s[74:75]
    s_nop 1
    v_mov_b32_dpp v32, v34 row_half_mirror row_mask:0xf bank_mask:0xf
    v_mov_b32_dpp v33, v34 row_half_mirror row_mask:0xf bank_mask:0xf
    s_nop 1
    v_permlane32_swap_b32 v32, v33
    v_cndmask_b32 v32, v33, v32, s[42:43]
    v_max_u32 v34, v34, v32
    s_nop 1
    v_max_u32_dpp v32, v34, v34 row_shl:4 row_mask:0xf bank_mask:0x5
    s_nop 1
    v_min_u32_dpp v32, v34, v34 row_shr:4 row_mask:0xf bank_mask:0xa
    s_nop 1
    v_max_u32_dpp v34, v32, v32 quad_perm:[2,3,0,1] row_mask:0xf bank_mask:0xf
    v_min_u32_dpp v32, v32, v32 quad_perm:[2,3,0,1] row_mask:0xf bank_mask:0xf
    v_cndmask_b32 v34, v34, v32, s[72:73]
    s_nop 1
    v_max_u32_dpp v32, v34, v34 quad_perm:[1,0,3,2] row_mask:0xf bank_mask:0xf
    v_min_u32_dpp v34, v34, v34 quad_perm:[1,0,3,2] row_mask:0xf bank_mask:0xf
    v_cndmask_b32 v34, v32, v34, s[74:75]
    v_and_b32 v35, 0x7ff, v34
    v_sub_u32 v35, 2047, v35
    v_mul_u32_u24 v37, 1280, v35
    v_add_u32 v36, v36, v37
    buffer_load_dwordx4 v[40:43], v36, s[20:23], 0 offen
    buffer_load_dwordx4 v[44:47], v36, s[20:23], 0 offen offset:128
    buffer_load_dwordx4 v[48:51], v36, s[20:23], 0 offen offset:256
    v_and_b32 v37, 0x7f8, v35
    v_add_u32 v37, v37, v35
    v_lshlrev_b32 v37, 3, v37
    buffer_load_dwordx2 v[38:39], v37, s[60:63], s77 offen sc1
    v_lshlrev_b32 v15, 2, v1
    v_mov_b32_dpp v52, v34 quad_perm:[0,2,0,2] row_mask:0xf bank_mask:0xf
    v_mov_b32_dpp v54, v34 quad_perm:[1,3,1,3] row_mask:0xf bank_mask:0xf
    v_mov_b32 v53, s56
    v_mov_b32 v55, s56
    s_mov_b64 exec, 0xff
    ds_write_b32 v15, v34 offset:61632
    ds_write_b32 v11, v12 offset:48
    v_lshrrev_b32 v15, 2, v1
    v_lshlrev_b32 v15, 5, v15
    v_and_b32 v32, 1, v1
    v_lshl_add_u32 v15, v32, 4, v15
    s_lshl_b32 s76, s16, 7
    s_add_u32 s76, s76, 4096
    s_or_b32 s40, s65, s3
    s_cmp_eq_u32 s40, 0
    s_cselect_b32 s76, s76, 0x80000000
    s_mov_b64 exec, 0x33
    buffer_store_dwordx4 v[52:55], v15, s[60:63], s76 offen sc1
    s_or_b32 s40, s64, s3
    s_cmp_eq_u32 s40, 0
    s_cselect_b32 s76, 0, 0x80000000
    s_mov_b64 exec, 1
    buffer_store_dword v53, v15, s[60:63], s76 offen sc1
    s_mov_b64 exec, -1
    v_lshrrev_b32 v4, 2, v2
    v_and_b32 v5, 3, v2
    v_lshlrev_b32 v6, 5, v4
    v_lshl_add_u32 v6, v5, 3, v6
    v_lshl_add_u32 v6, v3, 8, v6
    v_add_u32 v6, s68, v6
    v_lshl_add_u32 v13, v3, 2, v4
    v_mul_u32_u24 v13, 320, v13
    v_lshl_add_u32 v13, v5, 3, v13
    v_add_u32 v13, s68, v13
    v_lshlrev_b32 v14, 4, v1
    v_add_u32 v7, s68, v14
    s_waitcnt vmcnt(2)
    v_cmp_ne_u32 vcc, s56, v39
    s_cbranch_vccz FS0_30
    s_mov_b32 s57, 0
FS_31:
    buffer_load_dwordx2 v[38:39], v37, s[60:63], s77 offen sc1
    s_waitcnt vmcnt(0)
    v_cmp_ne_u32 vcc, s56, v39
    s_cbranch_vccz FS_31_x
    s_sleep 1
    s_add_u32 s57, s57, 1
    s_cmp_lt_u32 s57, 100000
    s_cbranch_scc1 FS_31
FS_31_x:
FS0_30:
    s_mov_b32 s57, 0
LW_32:
    ds_read_b32 v32, v11 offset:52
    s_waitcnt lgkmcnt(0)
    v_cmp_gt_u32 vcc, 4, v32
    s_cbranch_vccz LW_32_x
    s_add_u32 s57, s57, 1
    s_cmp_lt_u32 s57, 100000
    s_cbranch_scc1 LW_32
LW_32_x:
    v_and_b32 v39, 0xffff0000, v38
    v_lshlrev_b32 v38, 16, v38
    v_rcp_f32 v60, v39
    v_lshlrev_b32 v112, 16, v40
    v_and_b32 v113, 0xffff0000, v40
    ds_read_b64_tr_b16 v[72:73], v6 offset:0
    v_lshlrev_b32 v114, 16, v41
    v_and_b32 v115, 0xffff0000, v41
    ds_read_b64_tr_b16 v[74:75], v6 offset:128
    v_lshlrev_b32 v116, 16, v42
    v_and_b32 v117, 0xffff0000, v42
    ds_read_b64_tr_b16 v[76:77], v6 offset:20480
    v_lshlrev_b32 v118, 16, v43
    v_and_b32 v119, 0xffff0000, v43
    ds_read_b64_tr_b16 v[78:79], v6 offset:20608
    v_lshlrev_b32 v120, 16, v44
    v_and_b32 v121, 0xffff0000, v44
    ds_read_b64_tr_b16 v[88:89], v6 offset:2048
    v_lshlrev_b32 v122, 16, v45
    v_and_b32 v123, 0xffff0000, v45
    ds_read_b64_tr_b16 v[90:91], v6 offset:2176
    v_lshlrev_b32 v124, 16, v46
    v_and_b32 v125, 0xffff0000, v46
    ds_read_b64_tr_b16 v[92:93], v6 offset:22528
    v_lshlrev_b32 v126, 16, v47
    v_and_b32 v127, 0xffff0000, v47
    ds_read_b64_tr_b16 v[94:95], v6 offset:22656
    v_lshlrev_b32 v128, 16, v48
    v_and_b32 v129, 0xffff0000, v48
    ds_read_b64_tr_b16 v[104:105], v6 offset:4096
    v_lshlrev_b32 v130, 16, v49
    v_and_b32 v131, 0xffff0000, v49
    ds_read_b64_tr_b16 v[106:107], v6 offset:4224
    v_lshlrev_b32 v132, 16, v50
    v_and_b32 v133, 0xffff0000, v50
    ds_read_b64_tr_b16 v[108:109], v6 offset:24576
    v_lshlrev_b32 v134, 16, v51
    v_and_b32 v135, 0xffff0000, v51
    ds_read_b64_tr_b16 v[110:111], v6 offset:24704
    v_pk_add_f32 v[112:113], v[112:113], v[38:39] op_sel_hi:[1,0] neg_lo:[0,1] neg_hi:[0,1]
    ds_read_b64_tr_b16 v[80:81], v6 offset:1024
    v_pk_add_f32 v[114:115], v[114:115], v[38:39] op_sel_hi:[1,0] neg_lo:[0,1] neg_hi:[0,1]
    ds_read_b64_tr_b16 v[82:83], v6 offset:1152
    v_pk_add_f32 v[116:117], v[116:117], v[38:39] op_sel_hi:[1,0] neg_lo:[0,1] neg_hi:[0,1]
    ds_read_b64_tr_b16 v[84:85], v6 offset:21504
    v_pk_add_f32 v[118:119], v[118:119], v[38:39] op_sel_hi:[1,0] neg_lo:[0,1] neg_hi:[0,1]
    ds_read_b64_tr_b16 v[86:87], v6 offset:21632
    v_pk_add_f32 v[120:121], v[120:121], v[38:39] op_sel_hi:[1,0] neg_lo:[0,1] neg_hi:[0,1]
    ds_read_b64_tr_b16 v[96:97], v6 offset:3072
    v_pk_add_f32 v[122:123], v[122:123], v[38:39] op_sel_hi:[1,0] neg_lo:[0,1] neg_hi:[0,1]
    ds_read_b64_tr_b16 v[98:99], v6 offset:3200
    v_pk_add_f32 v[124:125], v[124:125], v[38:39] op_sel_hi:[1,0] neg_lo:[0,1] neg_hi:[0,1]
    ds_read_b64_tr_b16 v[100:101], v6 offset:23552
    v_pk_add_f32 v[126:127], v[126:127], v[38:39] op_sel_hi:[1,0] neg_lo:[0,1] neg_hi:[0,1]
    ds_read_b64_tr_b16 v[102:103], v6 offset:23680
    v_pk_add_f32 v[128:129], v[128:129], v[38:39] op_sel_hi:[1,0] neg_lo:[0,1] neg_hi:[0,1]
    v_pk_add_f32 v[130:131], v[130:131], v[38:39] op_sel_hi:[1,0] neg_lo:[0,1] neg_hi:[0,1]
    v_pk_add_f32 v[132:133], v[132:133], v[38:39] op_sel_hi:[1,0] neg_lo:[0,1] neg_hi:[0,1]
    v_pk_add_f32 v[134:135], v[134:135], v[38:39] op_sel_hi:[1,0] neg_lo:[0,1] neg_hi:[0,1]
    v_cvt_pk_bf16_f32 v40, v112, v113
    v_cvt_pk_bf16_f32 v41, v114, v115
    v_cvt_pk_bf16_f32 v42, v116, v117
    v_cvt_pk_bf16_f32 v43, v118, v119
    v_cvt_pk_bf16_f32 v44, v120, v121
    v_cvt_pk_bf16_f32 v45, v122, v123
    v_cvt_pk_bf16_f32 v46, v124, v125
    v_cvt_pk_bf16_f32 v47, v126, v127
    v_cvt_pk_bf16_f32 v48, v128, v129
    v_cvt_pk_bf16_f32 v49, v130, v131
    v_cvt_pk_bf16_f32 v50, v132, v133
    v_cvt_pk_bf16_f32 v51, v134, v135
    v_lshlrev_b32 v112, 16, v40
    v_and_b32 v113, 0xffff0000, v40
    v_lshlrev_b32 v114, 16, v41
    v_and_b32 v115, 0xffff0000, v41
    v_lshlrev_b32 v116, 16, v42
    v_and_b32 v117, 0xffff0000, v42
    v_lshlrev_b32 v118, 16, v43
    v_and_b32 v119, 0xffff0000, v43
    v_lshlrev_b32 v120, 16, v44
    v_and_b32 v121, 0xffff0000, v44
    v_lshlrev_b32 v122, 16, v45
    v_and_b32 v123, 0xffff0000, v45
    v_lshlrev_b32 v124, 16, v46
    v_and_b32 v125, 0xffff0000, v46
    v_lshlrev_b32 v126, 16, v47
    v_and_b32 v127, 0xffff0000, v47
    v_lshlrev_b32 v128, 16, v48
    v_and_b32 v129, 0xffff0000, v48
    v_lshlrev_b32 v130, 16, v49
    v_and_b32 v131, 0xffff0000, v49
    v_lshlrev_b32 v132, 16, v50
    v_and_b32 v133, 0xffff0000, v50
    v_lshlrev_b32 v134, 16, v51
    v_and_b32 v135, 0xffff0000, v51
    v_pk_mul_f32 v[112:113], v[112:113], v[60:61] op_sel_hi:[1,0]
    v_pk_mul_f32 v[114:115], v[114:115], v[60:61] op_sel_hi:[1,0]
    v_pk_mul_f32 v[116:117], v[116:117], v[60:61] op_sel_hi:[1,0]
    v_pk_mul_f32 v[118:119], v[118:119], v[60:61] op_sel_hi:[1,0]
    v_pk_mul_f32 v[120:121], v[120:121], v[60:61] op_sel_hi:[1,0]
    v_pk_mul_f32 v[122:123], v[122:123], v[60:61] op_sel_hi:[1,0]
    v_pk_mul_f32 v[124:125], v[124:125], v[60:61] op_sel_hi:[1,0]
    v_pk_mul_f32 v[126:127], v[126:127], v[60:61] op_sel_hi:[1,0]
    v_pk_mul_f32 v[128:129], v[128:129], v[60:61] op_sel_hi:[1,0]
    v_pk_mul_f32 v[130:131], v[130:131], v[60:61] op_sel_hi:[1,0]
    v_pk_mul_f32 v[132:133], v[132:133], v[60:61] op_sel_hi:[1,0]
    v_pk_mul_f32 v[134:135], v[134:135], v[60:61] op_sel_hi:[1,0]
    v_cvt_pk_bf16_f32 v40, v112, v113
    v_cvt_pk_bf16_f32 v41, v114, v115
    v_cvt_pk_bf16_f32 v42, v116, v117
    v_cvt_pk_bf16_f32 v43, v118, v119
    v_cvt_pk_bf16_f32 v44, v120, v121
    v_cvt_pk_bf16_f32 v45, v122, v123
    v_cvt_pk_bf16_f32 v46, v124, v125
    v_cvt_pk_bf16_f32 v47, v126, v127
    v_cvt_pk_bf16_f32 v48, v128, v129
    v_cvt_pk_bf16_f32 v49, v130, v131
    v_cvt_pk_bf16_f32 v50, v132, v133
    v_cvt_pk_bf16_f32 v51, v134, v135
    v_mov_b32 v39, v60
    v_mov_b32_dpp v52, v40 row_ror:8 row_mask:0xf bank_mask:0xf
    v_mov_b32_dpp v53, v41 row_ror:8 row_mask:0xf bank_mask:0xf
    v_mov_b32_dpp v54, v42 row_ror:8 row_mask:0xf bank_mask:0xf
    v_mov_b32_dpp v55, v43 row_ror:8 row_mask:0xf bank_mask:0xf
    v_mov_b32_dpp v56, v44 row_ror:8 row_mask:0xf bank_mask:0xf
    v_mov_b32_dpp v57, v45 row_ror:8 row_mask:0xf bank_mask:0xf
    v_mov_b32_dpp v58, v46 row_ror:8 row_mask:0xf bank_mask:0xf
    v_mov_b32_dpp v59, v47 row_ror:8 row_mask:0xf bank_mask:0xf
    s_waitcnt lgkmcnt(0)
    v_mfma_f32_16x16x32_bf16 v[60:63], v[72:75], v[40:43], 0
    v_mfma_f32_16x16x32_bf16 v[64:67], v[76:79], v[40:43], 0
    v_mfma_f32_16x16x32_bf16 v[60:63], v[88:91], v[44:47], v[60:63]
    v_mfma_f32_16x16x32_bf16 v[64:67], v[92:95], v[44:47], v[64:67]
    v_mfma_f32_16x16x32_bf16 v[60:63], v[104:107], v[48:51], v[60:63]
    v_mfma_f32_16x16x32_bf16 v[64:67], v[108:111], v[48:51], v[64:67]
    v_mfma_f32_16x16x32_bf16 v[60:63], v[80:83], v[52:55], v[60:63]
    v_mfma_f32_16x16x32_bf16 v[64:67], v[84:87], v[52:55], v[64:67]
    v_mfma_f32_16x16x32_bf16 v[60:63], v[96:99], v[56:59], v[60:63]
    v_mfma_f32_16x16x32_bf16 v[64:67], v[100:103], v[56:59], v[64:67]
    s_mov_b32 s40, 0x07060503
    s_mov_b32 s41, 0x07060502
    s_mov_b32 s43, 0x07060501
    s_nop 3
    ds_write_b128 v7, v[60:63] offset:0
    ds_write_b128 v7, v[64:67] offset:1024
    s_mov_b64 exec, 1
    ds_add_u32 v11, v12 offset:4
    s_mov_b64 exec, -1
    s_waitcnt vmcnt(0)
    s_mov_b32 s57, 0
LW_33:
    ds_read_b32 v32, v11 offset:56
    s_waitcnt lgkmcnt(0)
    v_cmp_gt_u32 vcc, 4, v32
    s_cbranch_vccz LW_33_x
    s_add_u32 s57, s57, 1
    s_cmp_lt_u32 s57, 100000
    s_cbranch_scc1 LW_33
LW_33_x:
    ds_read_b64_tr_b16 v[112:113], v13 offset:40960
    ds_read_b64_tr_b16 v[114:115], v13 offset:40992
    ds_read_b64_tr_b16 v[116:117], v13 offset:41024
    ds_read_b64_tr_b16 v[118:119], v13 offset:41056
    ds_read_b64_tr_b16 v[120:121], v13 offset:41088
    ds_read_b64_tr_b16 v[122:123], v13 offset:41120
    ds_read_b64_tr_b16 v[124:125], v13 offset:41152
    ds_read_b64_tr_b16 v[126:127], v13 offset:41184
    ds_read_b64_tr_b16 v[128:129], v13 offset:41216
    ds_read_b64_tr_b16 v[130:131], v13 offset:41248
    s_mov_b32 s57, 0
LW_34:
    ds_read_b32 v32, v11 offset:4
    s_waitcnt lgkmcnt(0)
    v_cmp_gt_u32 vcc, 4, v32
    s_cbranch_vccz LW_34_x
    s_add_u32 s57, s57, 1
    s_cmp_lt_u32 s57, 100000
    s_cbranch_scc1 LW_34
LW_34_x:
    ds_read_b128 v[72:75], v14 offset:0
    ds_read_b128 v[76:79], v14 offset:1024
    ds_read_b128 v[80:83], v14 offset:5120
    ds_read_b128 v[84:87], v14 offset:6144
    ds_read_b128 v[88:91], v14 offset:10240
    ds_read_b128 v[92:95], v14 offset:11264
    ds_read_b128 v[96:99], v14 offset:15360
    ds_read_b128 v[100:103], v14 offset:16384
    s_waitcnt lgkmcnt(0)
    v_pk_add_f32 v[72:73], v[72:73], v[80:81]
    v_pk_add_f32 v[88:89], v[88:89], v[96:97]
    v_pk_add_f32 v[74:75], v[74:75], v[82:83]
    v_pk_add_f32 v[90:91], v[90:91], v[98:99]
    v_pk_add_f32 v[76:77], v[76:77], v[84:85]
    v_pk_add_f32 v[92:93], v[92:93], v[100:101]
    v_pk_add_f32 v[78:79], v[78:79], v[86:87]
    v_pk_add_f32 v[94:95], v[94:95], v[102:103]
    v_pk_add_f32 v[72:73], v[72:73], v[88:89]
    v_pk_add_f32 v[74:75], v[74:75], v[90:91]
    v_pk_add_f32 v[76:77], v[76:77], v[92:93]
    v_pk_add_f32 v[78:79], v[78:79], v[94:95]
    v_cvt_pk_bf16_f32 v80, v72, v73
    v_cvt_pk_bf16_f32 v81, v74, v75
    v_cvt_pk_bf16_f32 v82, v76, v77
    v_cvt_pk_bf16_f32 v83, v78, v79
    v_lshlrev_b32 v72, 16, v80
    v_and_b32 v73, 0xffff0000, v80
    v_lshlrev_b32 v74, 16, v81
    v_and_b32 v75, 0xffff0000, v81
    v_lshlrev_b32 v76, 16, v82
    v_and_b32 v77, 0xffff0000, v82
    v_lshlrev_b32 v78, 16, v83
    v_and_b32 v79, 0xffff0000, v83
    v_mul_f32 v80, 3216550459, v72
    v_mul_f32 v81, 3216550459, v73
    v_mul_f32 v82, 3216550459, v74
    v_mul_f32 v83, 3216550459, v75
    v_exp_f32 v80, v80
    v_exp_f32 v81, v81
    v_exp_f32 v82, v82
    v_exp_f32 v83, v83
    v_add_f32 v80, 1.0, v80
    v_add_f32 v81, 1.0, v81
    v_add_f32 v82, 1.0, v82
    v_add_f32 v83, 1.0, v83
    v_rcp_f32 v80, v80
    v_rcp_f32 v81, v81
    v_rcp_f32 v82, v82
    v_rcp_f32 v83, v83
    v_mul_f32 v72, v72, v80
    v_mul_f32 v73, v73, v81
    v_mul_f32 v74, v74, v82
    v_mul_f32 v75, v75, v83
    v_cvt_pk_bf16_f32 v80, v72, v73
    v_cvt_pk_bf16_f32 v81, v74, v75
    v_lshlrev_b32 v72, 16, v80
    v_and_b32 v73, 0xffff0000, v80
    v_lshlrev_b32 v74, 16, v81
    v_and_b32 v75, 0xffff0000, v81
    v_pk_mul_f32 v[72:73], v[72:73], v[76:77]
    v_pk_mul_f32 v[74:75], v[74:75], v[78:79]
    v_cvt_pk_bf16_f32 v60, v72, v73
    v_cvt_pk_bf16_f32 v61, v74, v75
    s_nop 1
    v_mfma_f32_16x16x16_bf16 v[72:75], v[112:113], v[60:61], 0
    v_mfma_f32_16x16x16_bf16 v[76:79], v[114:115], v[60:61], 0
    v_mfma_f32_16x16x16_bf16 v[80:83], v[116:117], v[60:61], 0
    v_mfma_f32_16x16x16_bf16 v[84:87], v[118:119], v[60:61], 0
    v_mfma_f32_16x16x16_bf16 v[88:91], v[120:121], v[60:61], 0
    v_mfma_f32_16x16x16_bf16 v[92:95], v[122:123], v[60:61], 0
    v_mfma_f32_16x16x16_bf16 v[96:99], v[124:125], v[60:61], 0
    v_mfma_f32_16x16x16_bf16 v[100:103], v[126:127], v[60:61], 0
    v_mfma_f32_16x16x16_bf16 v[104:107], v[128:129], v[60:61], 0
    v_mfma_f32_16x16x16_bf16 v[108:111], v[130:131], v[60:61], 0
    s_mov_b32 exec_lo, 0x00ff00ff
    s_mov_b32 exec_hi, 0x00ff00ff
    v_perm_b32 v72, v72, v75, s40
    v_perm_b32 v73, v73, v75, s41
    v_perm_b32 v74, v74, v75, s43
    v_mov_b32 v75, s56
    buffer_store_dwordx4 v[72:75], v10, s[60:63], s66 offen offset:0 sc1
    v_perm_b32 v76, v76, v79, s40
    v_perm_b32 v77, v77, v79, s41
    v_perm_b32 v78, v78, v79, s43
    v_mov_b32 v79, s56
    buffer_store_dwordx4 v[76:79], v10, s[60:63], s66 offen offset:512 sc1
    v_perm_b32 v80, v80, v83, s40
    v_perm_b32 v81, v81, v83, s41
    v_perm_b32 v82, v82, v83, s43
    v_mov_b32 v83, s56
    buffer_store_dwordx4 v[80:83], v10, s[60:63], s66 offen offset:1024 sc1
    v_perm_b32 v84, v84, v87, s40
    v_perm_b32 v85, v85, v87, s41
    v_perm_b32 v86, v86, v87, s43
    v_mov_b32 v87, s56
    buffer_store_dwordx4 v[84:87], v10, s[60:63], s66 offen offset:1536 sc1
    v_perm_b32 v88, v88, v91, s40
    v_perm_b32 v89, v89, v91, s41
    v_perm_b32 v90, v90, v91, s43
    v_mov_b32 v91, s56
    buffer_store_dwordx4 v[88:91], v10, s[60:63], s66 offen offset:2048 sc1
    v_perm_b32 v92, v92, v95, s40
    v_perm_b32 v93, v93, v95, s41
    v_perm_b32 v94, v94, v95, s43
    v_mov_b32 v95, s56
    buffer_store_dwordx4 v[92:95], v10, s[60:63], s66 offen offset:2560 sc1
    v_perm_b32 v96, v96, v99, s40
    v_perm_b32 v97, v97, v99, s41
    v_perm_b32 v98, v98, v99, s43
    v_mov_b32 v99, s56
    buffer_store_dwordx4 v[96:99], v10, s[60:63], s66 offen offset:3072 sc1
    v_perm_b32 v100, v100, v103, s40
    v_perm_b32 v101, v101, v103, s41
    v_perm_b32 v102, v102, v103, s43
    v_mov_b32 v103, s56
    buffer_store_dwordx4 v[100:103], v10, s[60:63], s66 offen offset:3584 sc1
    v_perm_b32 v104, v104, v107, s40
    v_perm_b32 v105, v105, v107, s41
    v_perm_b32 v106, v106, v107, s43
    v_mov_b32 v107, s56
    s_add_u32 s66, s66, 4096
    buffer_store_dwordx4 v[104:107], v10, s[60:63], s66 offen offset:0 sc1
    v_perm_b32 v108, v108, v111, s40
    v_perm_b32 v109, v109, v111, s41
    v_perm_b32 v110, v110, v111, s43
    v_mov_b32 v111, s56
    buffer_store_dwordx4 v[108:111], v10, s[60:63], s66 offen offset:512 sc1
    s_mov_b64 exec, -1
    s_cmp_ge_u32 s64, 80
    s_cbranch_scc1 K_END
    s_cmp_ge_u32 s3, 2
    s_cbranch_scc1 K_END
    s_lshl_b32 s42, s64, 1
    s_add_u32 s42, s42, s3
    s_lshl_b32 s50, s42, 7
    v_mov_b32 v6, 131072
    buffer_load_dword v16, v6, s[60:63], s50 offen sc1
    v_lshrrev_b32 v4, 3, v1
    v_and_b32 v15, 7, v1
    v_mul_u32_u24 v5, 20480, v4
    v_lshl_add_u32 v5, v15, 4, v5
    s_add_u32 s40, s50, 8388608
    v_add_u32 v5, s40, v5
    v_and_b32 v4, 3, v4
    s_lshl_b32 s42, s42, 2
    v_add_u32 v8, s42, v4
    v_mul_u32_u24 v9, 1280, v35
    v_lshl_add_u32 v9, v8, 1, v9
    buffer_load_ushort v12, v9, s[20:23], 0 offen
    v_lshlrev_b32 v13, 1, v35
    v_and_b32 v13, 0xfffffffc, v13
    v_mul_u32_u24 v8, 4224, v8
    s_mov_b32 s47, 4194304
    v_add3_u32 v8, v8, v13, s47
    v_cmp_eq_u32 s[72:73], 1, v4
    v_cmp_eq_u32 s[74:75], 2, v4
    v_cmp_eq_u32 s[76:77], 3, v4
    v_ashrrev_i32 v20, 31, v34
    v_not_b32 v20, v20
    v_or_b32 v20, 0x80000000, v20
    v_xor_b32 v20, v20, v34
    v_and_b32 v20, 0xffff0000, v20
    v_mul_f32 v20, 3216550459, v20
    v_exp_f32 v20, v20
    v_and_b32 v23, 1, v35
    v_xor_b32 v23, 1, v23
    v_lshlrev_b32 v23, 4, v23
    v_add_f32 v20, 1.0, v20
    v_rcp_f32 v20, v20
    s_or_b64 s[74:75], s[74:75], s[76:77]
    s_mov_b32 s24, s52
    s_mov_b32 s25, s53
    s_mov_b32 s26, 2621440
    s_mov_b32 s27, 0x20000
    s_mov_b32 s28, 0
    s_mov_b32 s29, 163840
    s_mov_b32 s30, 327680
    s_mov_b32 s31, 491520
    s_mov_b32 s32, 655360
    s_mov_b32 s33, 819200
    s_mov_b32 s34, 983040
    s_mov_b32 s35, 1146880
    s_mov_b32 s36, 1310720
    s_mov_b32 s37, 1474560
    s_mov_b32 s38, 1638400
    s_mov_b32 s39, 1802240
    v_cvt_pk_bf16_f32 v20, v20, v20
    v_and_b32 v20, 0xffff0000, v20
    s_waitcnt vmcnt(0)
    v_lshlrev_b32 v21, 16, v12
    v_sub_f32 v22, v21, v38
    v_cvt_pk_bf16_f32 v22, v22, v22
    v_and_b32 v22, 0xffff0000, v22
    v_mul_f32 v22, v39, v22
    v_cvt_pk_bf16_f32 v22, v22, v22
    v_and_b32 v22, 0xffff0000, v22
    v_cmp_ne_u32 vcc, s56, v16
    s_cbranch_vccz RG0_35
    s_mov_b32 s57, 0
RG_36:
    buffer_load_dword v16, v6, s[60:63], s50 offen sc1
    s_waitcnt vmcnt(0)
    v_cmp_ne_u32 vcc, s56, v16
    s_cbranch_vccz RG_36_x
    s_sleep 2
    s_add_u32 s57, s57, 1
    s_cmp_lt_u32 s57, 100000
    s_cbranch_scc1 RG_36
RG_36_x:
RG0_35:
    s_mov_b32 s40, 0x04000c0c
    s_mov_b32 s41, 0x0706000c
    s_sleep 16
    s_mov_b32 s57, 0
RP_37:
    buffer_load_dwordx4 v[40:43], v5, s[60:63], s28 offen sc1
    buffer_load_dwordx4 v[44:47], v5, s[60:63], s29 offen sc1
    buffer_load_dwordx4 v[48:51], v5, s[60:63], s30 offen sc1
    buffer_load_dwordx4 v[52:55], v5, s[60:63], s31 offen sc1
    buffer_load_dwordx4 v[56:59], v5, s[60:63], s32 offen sc1
    buffer_load_dwordx4 v[60:63], v5, s[60:63], s33 offen sc1
    buffer_load_dwordx4 v[64:67], v5, s[60:63], s34 offen sc1
    buffer_load_dwordx4 v[68:71], v5, s[60:63], s35 offen sc1
    buffer_load_dwordx4 v[72:75], v5, s[60:63], s36 offen sc1
    buffer_load_dwordx4 v[76:79], v5, s[60:63], s37 offen sc1
    buffer_load_dwordx4 v[80:83], v5, s[60:63], s38 offen sc1
    buffer_load_dwordx4 v[84:87], v5, s[60:63], s39 offen sc1
    s_waitcnt vmcnt(0)
    v_max3_u32 v18, v43, v47, v51
    v_max3_u32 v18, v18, v55, v59
    v_max3_u32 v18, v18, v63, v67
    v_max3_u32 v18, v18, v71, v75
    v_max3_u32 v18, v18, v79, v83
    v_max_u32 v18, v18, v87
    v_min3_u32 v19, v43, v47, v51
    v_min3_u32 v19, v19, v55, v59
    v_min3_u32 v19, v19, v63, v67
    v_min3_u32 v19, v19, v71, v75
    v_min3_u32 v19, v19, v79, v83
    v_min_u32 v19, v19, v87
    v_xor_b32 v18, s56, v18
    v_xor_b32 v19, s56, v19
    v_or_b32 v18, v18, v19
    v_cmp_ne_u32 vcc, 0, v18
    s_and_b64 exec, exec, vcc
    s_cbranch_execz RP_37_x
    s_sleep 1
    s_add_u32 s57, s57, 1
    s_cmp_lt_u32 s57, 100000
    s_cbranch_scc1 RP_37
RP_37_x:
    s_mov_b64 exec, -1
    s_mov_b32 exec_hi, 0
    buffer_load_dword v13, v8, s[60:63], 0 offen sc1
    s_mov_b32 exec_hi, -1
    v_perm_b32 v43, v40, v41, s40
    v_perm_b32 v47, v44, v45, s40
    v_perm_b32 v51, v48, v49, s40
    v_perm_b32 v55, v52, v53, s40
    v_perm_b32 v59, v56, v57, s40
    v_perm_b32 v63, v60, v61, s40
    v_perm_b32 v67, v64, v65, s40
    v_perm_b32 v71, v68, v69, s40
    v_perm_b32 v75, v72, v73, s40
    v_perm_b32 v79, v76, v77, s40
    v_perm_b32 v83, v80, v81, s40
    v_perm_b32 v87, v84, v85, s40
    v_perm_b32 v43, v43, v42, s41
    v_perm_b32 v47, v47, v46, s41
    v_perm_b32 v51, v51, v50, s41
    v_perm_b32 v55, v55, v54, s41
    v_perm_b32 v59, v59, v58, s41
    v_perm_b32 v63, v63, v62, s41
    v_perm_b32 v67, v67, v66, s41
    v_perm_b32 v71, v71, v70, s41
    v_perm_b32 v75, v75, v74, s41
    v_perm_b32 v79, v79, v78, s41
    v_perm_b32 v83, v83, v82, s41
    v_perm_b32 v87, v87, v86, s41
    v_pk_add_f32 v[40:41], v[40:41], v[64:65]
    v_pk_add_f32 v[42:43], v[42:43], v[66:67]
    v_pk_add_f32 v[44:45], v[44:45], v[68:69]
    v_pk_add_f32 v[46:47], v[46:47], v[70:71]
    v_pk_add_f32 v[48:49], v[48:49], v[72:73]
    v_pk_add_f32 v[50:51], v[50:51], v[74:75]
    v_pk_add_f32 v[52:53], v[52:53], v[76:77]
    v_pk_add_f32 v[54:55], v[54:55], v[78:79]
    v_pk_add_f32 v[56:57], v[56:57], v[80:81]
    v_pk_add_f32 v[58:59], v[58:59], v[82:83]
    v_pk_add_f32 v[60:61], v[60:61], v[84:85]
    v_pk_add_f32 v[62:63], v[62:63], v[86:87]
    v_pk_add_f32 v[40:41], v[40:41], v[52:53]
    v_pk_add_f32 v[42:43], v[42:43], v[54:55]
    v_pk_add_f32 v[44:45], v[44:45], v[56:57]
    v_pk_add_f32 v[46:47], v[46:47], v[58:59]
    v_pk_add_f32 v[48:49], v[48:49], v[60:61]
    v_pk_add_f32 v[50:51], v[50:51], v[62:63]
    v_pk_add_f32 v[40:41], v[40:41], v[44:45]
    v_pk_add_f32 v[42:43], v[42:43], v[46:47]
    v_pk_add_f32 v[40:41], v[40:41], v[48:49]
    v_pk_add_f32 v[42:43], v[42:43], v[50:51]
    s_nop 0
    v_add_f32_dpp v40, v40, v40 row_ror:8 row_mask:0xf bank_mask:0xf
    v_add_f32_dpp v41, v41, v41 row_ror:8 row_mask:0xf bank_mask:0xf
    v_add_f32_dpp v42, v42, v42 row_ror:8 row_mask:0xf bank_mask:0xf
    v_add_f32_dpp v43, v43, v43 row_ror:8 row_mask:0xf bank_mask:0xf
    v_mov_b32 v44, v40
    v_mov_b32 v45, v41
    v_mov_b32 v46, v42
    v_mov_b32 v47, v43
    v_permlane16_swap_b32 v40, v44
    v_permlane16_swap_b32 v41, v45
    v_permlane16_swap_b32 v42, v46
    v_permlane16_swap_b32 v43, v47
    v_pk_add_f32 v[40:41], v[40:41], v[44:45]
    v_pk_add_f32 v[42:43], v[42:43], v[46:47]
    v_cndmask_b32 v40, v40, v41, s[72:73]
    v_cndmask_b32 v42, v42, v43, s[76:77]
    v_cndmask_b32 v40, v40, v42, s[74:75]
    v_mov_b32 v41, v40
    s_nop 1
    v_permlane32_swap_b32 v40, v41
    v_add_f32 v40, v40, v41
    v_cvt_pk_bf16_f32 v40, v40, v40
    v_and_b32 v40, 0xffff0000, v40
    v_mul_f32 v40, v40, v20
    v_cvt_pk_bf16_f32 v40, v40, v40
    v_and_b32 v40, 0xffff0000, v40
    v_add_f32 v40, v40, v22
    v_cvt_pk_bf16_f32 v40, v40, v40
    v_and_b32 v40, 0xffff0000, v40
    v_mul_f32 v41, 3216550459, v40
    v_exp_f32 v41, v41
    s_nop 0
    v_add_f32 v41, 1.0, v41
    v_rcp_f32 v41, v41
    s_nop 0
    v_mul_f32 v40, v40, v41
    v_mul_f32 v22, v22, v40
    s_mov_b32 exec_hi, 0
    s_waitcnt vmcnt(0)
    v_cmp_eq_u32 vcc, -1, v13
    s_cbranch_vccz RY0_38
    s_mov_b32 s57, 0
RY_39:
    buffer_load_dword v13, v8, s[60:63], 0 offen sc1
    s_waitcnt vmcnt(0)
    v_cmp_eq_u32 vcc, -1, v13
    s_cbranch_vccz RY_39_x
    s_sleep 2
    s_add_u32 s57, s57, 1
    s_cmp_lt_u32 s57, 100000
    s_cbranch_scc1 RY_39
RY_39_x:
RY0_38:
    v_lshlrev_b32 v13, v23, v13
    v_and_b32 v13, 0xffff0000, v13
    v_fma_f32 v22, v22, v13, v21
    v_cvt_pk_bf16_f32 v22, v22, v22
    buffer_store_short v22, v9, s[24:27], 0 offen
    s_endpgm
K_END:
    s_endpgm
.section .rodata,"a"
.p2align 6
.amdhsa_kernel recurrent_scan__ssm_conv_h3__moe_arch_mod__prompt_kernel
  .amdhsa_next_free_vgpr 149
  .amdhsa_next_free_sgpr 80
  .amdhsa_accum_offset 152
  .amdhsa_group_segment_fixed_size 0
  .amdhsa_kernarg_size 112
  .amdhsa_user_sgpr_count 2
  .amdhsa_user_sgpr_kernarg_segment_ptr 1
  .amdhsa_system_sgpr_workgroup_id_x 1
  .amdhsa_float_denorm_mode_32 3
.end_amdhsa_kernel
```
